```python
import torch

def _softmax(x, axis=-1):
    return torch.softmax(x, dim=axis)
def _gelu(x):
    return torch.nn.functional.gelu(x, approximate="tanh")
def _silu(x):
    return torch.nn.functional.silu(x)
def _sigmoid(x):
    return torch.sigmoid(x)
def _layernorm(x, axis=-1, eps=1e-5):
    m = x.mean(dim=axis, keepdim=True)
    v = x.var(dim=axis, keepdim=True, unbiased=False)
    return (x - m) / torch.sqrt(v + eps)
def _scatter_add(tgt, idx, src, axis=0):
    return tgt.clone().index_add_(axis, idx, src)
def _segment_sum(src, seg, n):
    out = torch.zeros((n,) + src.shape[1:], dtype=src.dtype)
    return out.index_add_(0, seg, src)
def _pad(x, pw):
    flat = tuple(v for pair in reversed(pw) for v in pair)
    return torch.nn.functional.pad(x, flat)

kernel_name = 'standalone__attention_interact_autoint__recsys'

def setup_inputs():

    _w = (lambda a: (lambda t: t.to(torch.bfloat16) if t.is_floating_point() else t)(torch.as_tensor(a)))
    B, F = 4096, 100
    D = max(2, (16 // 2) * 2)
    H = 2
    Dh = D // H
    return {
        "e": _w((lambda *s: torch.randn(*s, dtype=torch.bfloat16) * 0.05)(B, F, D).to(float)),
        "wq": _w((lambda *s: torch.randn(*s, dtype=torch.bfloat16) * 6.4)(H, D, Dh).to(float)),
        "wk": _w((lambda *s: torch.randn(*s, dtype=torch.bfloat16) * 6.4)(H, D, Dh).to(float)),
        "wv": _w((lambda *s: torch.randn(*s, dtype=torch.bfloat16) * 0.05)(H, D, Dh).to(float)),
        "wres": _w((lambda *s: torch.randn(*s, dtype=torch.bfloat16) * 0.05)(D, D).to(float)),
    }

def reference(e, wq, wk, wv, wres):
    H, D, Dh = wq.shape[0], wq.shape[1], wq.shape[2]
    B, F = e.shape[0], e.shape[1]
    q = torch.einsum('bfd,hdk->bhfk', e, wq)
    k = torch.einsum('bfd,hdk->bhfk', e, wk)
    v = torch.einsum('bfd,hdk->bhfk', e, wv)
    scale = float(Dh) ** -0.5
    scores = torch.einsum('bhfk,bhgk->bhfg', q, k) * scale
    attn = _softmax(scores, axis=-1)
    attn = (lambda x, dt: x.to(dt))(attn, v.dtype)
    ctx = torch.einsum('bhfg,bhgk->bhfk', attn, v)
    ctx = (lambda x, *d: x.permute(*d))(ctx, 0, 2, 1, 3).reshape(B, F, H * Dh)
    res = torch.einsum('bfd,de->bfe', e, wres)
    out = ctx + res
    mask = (lambda x, dt: x.to(dt))(out > 0, out.dtype)
    return out * mask
```

```asm
; @launch grid=(256,1,1) block=(1024,1,1) lds=0
.amdgcn_target "amdgcn-amd-amdhsa--gfx950"
.text
.globl standalone__attention_interact_autoint__recsys_kernel
.p2align 8
.type standalone__attention_interact_autoint__recsys_kernel,@function
standalone__attention_interact_autoint__recsys_kernel:
    s_load_dwordx4 s[4:7], s[0:1], 0
    s_load_dwordx4 s[8:11], s[0:1], 16
    s_load_dwordx4 s[12:15], s[0:1], 32
    v_lshrrev_b32 v7, 6, v0
    s_nop 0
    v_readfirstlane_b32 s3, v7
    s_mul_i32 s33, s2, 16
    s_add_u32 s33, s33, s3
    s_cmp_ge_u32 s33, 4096
    s_cbranch_scc1 L_end
    v_and_b32 v112, 63, v0
    v_and_b32 v113, 15, v112
    v_lshrrev_b32 v114, 4, v112
    v_and_b32 v116, 3, v113
    v_lshlrev_b32 v1, 5, v113
    v_lshl_add_u32 v2, v114, 2, v1
    v_lshl_add_u32 v1, v114, 3, v1
    v_mov_b32 v47, 0x10000
    v_lshlrev_b32 v115, 3, v113
    v_lshl_add_u32 v115, v114, 3, v115
    v_add_u32 v115, 3072, v115
    v_cmp_eq_u32 vcc, 0, v116
    s_nop 1
    v_cndmask_b32 v115, v47, v115, vcc
    v_lshlrev_b32 v118, 5, v116
    v_lshl_add_u32 v119, v114, 2, v118
    v_lshl_add_u32 v118, v114, 3, v118
    v_add_u32 v118, 3072, v118
    v_add_u32 v119, 3072, v119
    v_cmp_gt_u32 vcc, 8, v113
    s_nop 1
    v_cndmask_b32 v118, v47, v118, vcc
    v_cmp_gt_u32 vcc, 4, v113
    s_nop 1
    v_cndmask_b32 v3, v47, v119, vcc
    v_lshrrev_b32 v117, 2, v113
    v_cmp_eq_u32 vcc, 1, v117
    s_nop 1
    v_cndmask_b32 v4, v47, v119, vcc
    v_lshlrev_b32 v44, 4, v113
    v_lshl_add_u32 v44, v114, 3, v44
    v_cmp_gt_u32 vcc, 2, v114
    s_nop 1
    v_cndmask_b32 v44, v47, v44, vcc
    v_lshl_add_u32 v117, v117, 1, v116
    v_lshlrev_b32 v117, 1, v117
    v_lshl_add_u32 v45, v114, 6, v117
    v_lshl_add_u32 v46, v114, 7, v117
    v_cmp_gt_u32 vcc, 2, v116
    s_nop 1
    v_cndmask_b32 v45, v47, v45, vcc
    v_cndmask_b32 v46, v47, v46, vcc
    v_mov_b32 v9, 0
    v_mov_b32 v6, 0x7fff7fff
    v_cmp_eq_u32 vcc, 2, v116
    v_mov_b32 v117, 1.0
    s_nop 0
    v_cndmask_b32 v88, v9, v117, vcc
    v_mov_b32 v89, v88
    v_mov_b32 v90, v88
    v_mov_b32 v91, v88
    s_mov_b32 s48, 0x00f000f0
    s_mov_b32 s49, 0x00f000f0
    s_mov_b32 s44, 0
    s_mov_b64 s[46:47], 0
    s_waitcnt lgkmcnt(0)
    s_mul_i32 s34, s33, 3200
    s_add_u32 s16, s4, s34
    s_addc_u32 s17, s5, 0
    s_mov_b32 s18, 3200
    s_mov_b32 s19, 0x00020000
    s_add_u32 s20, s14, s34
    s_addc_u32 s21, s15, 0
    s_mov_b32 s22, 3200
    s_mov_b32 s23, 0x00020000
    s_mov_b32 s24, s6
    s_mov_b32 s25, s7
    s_mov_b32 s26, 512
    s_mov_b32 s27, 0x00020000
    s_mov_b32 s28, s8
    s_mov_b32 s29, s9
    s_mov_b32 s30, 512
    s_mov_b32 s31, 0x00020000
    s_mov_b32 s36, s10
    s_mov_b32 s37, s11
    s_mov_b32 s38, 512
    s_mov_b32 s39, 0x00020000
    s_mov_b32 s40, s12
    s_mov_b32 s41, s13
    s_mov_b32 s42, 512
    s_mov_b32 s43, 0x00020000
    buffer_load_dwordx2 v[100:101], v44, s[24:27], 0 offen offset:0
    buffer_load_dwordx2 v[102:103], v44, s[28:31], 0 offen offset:0
    buffer_load_dwordx2 v[104:105], v44, s[24:27], 0 offen offset:256
    buffer_load_dwordx2 v[106:107], v44, s[28:31], 0 offen offset:256
    buffer_load_ushort v92, v45, s[36:39], 0 offen offset:0
    buffer_load_ushort v93, v45, s[36:39], 0 offen offset:16
    buffer_load_ushort v94, v45, s[36:39], 0 offen offset:32
    buffer_load_ushort v95, v45, s[36:39], 0 offen offset:48
    buffer_load_ushort v96, v45, s[36:39], 0 offen offset:256
    buffer_load_ushort v97, v45, s[36:39], 0 offen offset:272
    buffer_load_ushort v98, v45, s[36:39], 0 offen offset:288
    buffer_load_ushort v99, v45, s[36:39], 0 offen offset:304
    buffer_load_ushort v36, v46, s[40:43], 0 offen offset:0
    buffer_load_ushort v37, v46, s[40:43], 0 offen offset:32
    buffer_load_ushort v38, v46, s[40:43], 0 offen offset:64
    buffer_load_ushort v39, v46, s[40:43], 0 offen offset:96
    buffer_load_ushort v40, v46, s[40:43], 0 offen offset:16
    buffer_load_ushort v41, v46, s[40:43], 0 offen offset:48
    buffer_load_ushort v42, v46, s[40:43], 0 offen offset:80
    buffer_load_ushort v43, v46, s[40:43], 0 offen offset:112
    buffer_load_dwordx2 v[10:11], v1, s[16:19], 0 offen offset:0
    buffer_load_dwordx2 v[12:13], v1, s[16:19], 0 offen offset:512
    buffer_load_dwordx2 v[14:15], v1, s[16:19], 0 offen offset:1024
    buffer_load_dwordx2 v[16:17], v1, s[16:19], 0 offen offset:1536
    buffer_load_dwordx2 v[18:19], v1, s[16:19], 0 offen offset:2048
    buffer_load_dwordx2 v[20:21], v1, s[16:19], 0 offen offset:2560
    buffer_load_dwordx2 v[22:23], v115, s[16:19], 0 offen
    buffer_load_dwordx2 v[24:25], v118, s[16:19], 0 offen
    s_waitcnt vmcnt(8)
    v_lshl_or_b32 v84, v93, 16, v92
    v_lshl_or_b32 v30, v37, 16, v36
    v_lshl_or_b32 v85, v95, 16, v94
    v_lshl_or_b32 v31, v39, 16, v38
    v_lshl_or_b32 v86, v97, 16, v96
    v_lshl_or_b32 v32, v41, 16, v40
    v_lshl_or_b32 v87, v99, 16, v98
    v_lshl_or_b32 v33, v43, 16, v42
    v_mfma_f32_16x16x16_bf16 v[108:111], v[100:101], v[102:103], 0
    s_nop 7
    v_mul_f32 v108, 0x3f0293ee, v108
    v_mul_f32 v109, 0x3f0293ee, v109
    v_mul_f32 v110, 0x3f0293ee, v110
    v_mul_f32 v111, 0x3f0293ee, v111
    v_cvt_pk_bf16_f32 v26, v108, v109
    v_cvt_pk_bf16_f32 v27, v110, v111
    v_mfma_f32_16x16x16_bf16 v[108:111], v[104:105], v[106:107], 0
    s_nop 7
    v_mul_f32 v108, 0x3f0293ee, v108
    v_mul_f32 v109, 0x3f0293ee, v109
    v_mul_f32 v110, 0x3f0293ee, v110
    v_mul_f32 v111, 0x3f0293ee, v111
    v_cvt_pk_bf16_f32 v28, v108, v109
    v_cvt_pk_bf16_f32 v29, v110, v111
    s_waitcnt vmcnt(0)
    v_and_b32 v34, v6, v10
    v_and_b32 v35, v6, v11
    v_and_b32 v116, v6, v12
    v_pk_max_u16 v34, v34, v116
    v_and_b32 v117, v6, v13
    v_pk_max_u16 v35, v35, v117
    v_and_b32 v116, v6, v14
    v_pk_max_u16 v34, v34, v116
    v_and_b32 v117, v6, v15
    v_pk_max_u16 v35, v35, v117
    v_and_b32 v116, v6, v16
    v_pk_max_u16 v34, v34, v116
    v_and_b32 v117, v6, v17
    v_pk_max_u16 v35, v35, v117
    v_and_b32 v116, v6, v18
    v_pk_max_u16 v34, v34, v116
    v_and_b32 v117, v6, v19
    v_pk_max_u16 v35, v35, v117
    v_and_b32 v116, v6, v20
    v_pk_max_u16 v34, v34, v116
    v_and_b32 v117, v6, v21
    v_pk_max_u16 v35, v35, v117
    v_and_b32 v116, v6, v22
    v_pk_max_u16 v34, v34, v116
    v_and_b32 v117, v6, v23
    v_pk_max_u16 v35, v35, v117
    v_mov_b32_dpp v116, v34 row_ror:8 row_mask:0xf bank_mask:0xf
    v_pk_max_u16 v34, v34, v116
    v_mov_b32_dpp v117, v35 row_ror:8 row_mask:0xf bank_mask:0xf
    v_pk_max_u16 v35, v35, v117
    v_mov_b32_dpp v116, v34 row_ror:4 row_mask:0xf bank_mask:0xf
    v_pk_max_u16 v34, v34, v116
    v_mov_b32_dpp v117, v35 row_ror:4 row_mask:0xf bank_mask:0xf
    v_pk_max_u16 v35, v35, v117
    v_mov_b32_dpp v116, v34 row_ror:2 row_mask:0xf bank_mask:0xf
    v_pk_max_u16 v34, v34, v116
    v_mov_b32_dpp v117, v35 row_ror:2 row_mask:0xf bank_mask:0xf
    v_pk_max_u16 v35, v35, v117
    v_mov_b32_dpp v116, v34 row_ror:1 row_mask:0xf bank_mask:0xf
    v_pk_max_u16 v34, v34, v116
    v_mov_b32_dpp v117, v35 row_ror:1 row_mask:0xf bank_mask:0xf
    v_pk_max_u16 v35, v35, v117
    v_lshlrev_b32 v116, 16, v34
    v_and_b32 v117, 0xffff0000, v34
    v_mul_f32 v116, 0xbf840000, v116
    v_mul_f32 v117, 0xbf840000, v117
    v_cvt_pk_bf16_f32 v34, v116, v117
    v_lshlrev_b32 v116, 16, v35
    v_and_b32 v117, 0xffff0000, v35
    v_mul_f32 v116, 0xbf840000, v116
    v_mul_f32 v117, 0xbf840000, v117
    v_cvt_pk_bf16_f32 v35, v116, v117
    v_mfma_f32_16x16x16_bf16 v[92:95], v[10:11], v[84:85], v[88:91]
    s_nop 7
    v_cvt_pk_bf16_f32 v58, v92, v93
    v_cvt_pk_bf16_f32 v59, v94, v95
    v_mfma_f32_16x16x16_bf16 v[96:99], v[10:11], v[86:87], v[88:91]
    s_nop 7
    v_cvt_pk_bf16_f32 v72, v96, v97
    v_cvt_pk_bf16_f32 v73, v98, v99
    v_mfma_f32_16x16x16_bf16 v[92:95], v[12:13], v[84:85], v[88:91]
    s_nop 7
    v_cvt_pk_bf16_f32 v60, v92, v93
    v_cvt_pk_bf16_f32 v61, v94, v95
    v_mfma_f32_16x16x16_bf16 v[96:99], v[12:13], v[86:87], v[88:91]
    s_nop 7
    v_cvt_pk_bf16_f32 v74, v96, v97
    v_cvt_pk_bf16_f32 v75, v98, v99
    v_mfma_f32_16x16x16_bf16 v[92:95], v[14:15], v[84:85], v[88:91]
    s_nop 7
    v_cvt_pk_bf16_f32 v62, v92, v93
    v_cvt_pk_bf16_f32 v63, v94, v95
    v_mfma_f32_16x16x16_bf16 v[96:99], v[14:15], v[86:87], v[88:91]
    s_nop 7
    v_cvt_pk_bf16_f32 v76, v96, v97
    v_cvt_pk_bf16_f32 v77, v98, v99
    v_mfma_f32_16x16x16_bf16 v[92:95], v[16:17], v[84:85], v[88:91]
    s_nop 7
    v_cvt_pk_bf16_f32 v64, v92, v93
    v_cvt_pk_bf16_f32 v65, v94, v95
    v_mfma_f32_16x16x16_bf16 v[96:99], v[16:17], v[86:87], v[88:91]
    s_nop 7
    v_cvt_pk_bf16_f32 v78, v96, v97
    v_cvt_pk_bf16_f32 v79, v98, v99
    v_mfma_f32_16x16x16_bf16 v[92:95], v[18:19], v[84:85], v[88:91]
    s_nop 7
    v_cvt_pk_bf16_f32 v66, v92, v93
    v_cvt_pk_bf16_f32 v67, v94, v95
    v_mfma_f32_16x16x16_bf16 v[96:99], v[18:19], v[86:87], v[88:91]
    s_nop 7
    v_cvt_pk_bf16_f32 v80, v96, v97
    v_cvt_pk_bf16_f32 v81, v98, v99
    v_mfma_f32_16x16x16_bf16 v[92:95], v[20:21], v[84:85], v[88:91]
    s_nop 7
    v_cvt_pk_bf16_f32 v68, v92, v93
    v_cvt_pk_bf16_f32 v69, v94, v95
    v_mfma_f32_16x16x16_bf16 v[96:99], v[20:21], v[86:87], v[88:91]
    s_nop 7
    v_cvt_pk_bf16_f32 v82, v96, v97
    v_cvt_pk_bf16_f32 v83, v98, v99
    v_mfma_f32_16x16x16_bf16 v[92:95], v[22:23], v[84:85], v[88:91]
    s_nop 7
    v_cvt_pk_bf16_f32 v56, v92, v93
    v_cvt_pk_bf16_f32 v57, v94, v95
    v_mfma_f32_16x16x16_bf16 v[96:99], v[22:23], v[86:87], v[88:91]
    s_nop 7
    v_cvt_pk_bf16_f32 v70, v96, v97
    v_cvt_pk_bf16_f32 v71, v98, v99
    v_mov_b32 v117, 0
    v_mov_b32 v118, 0
    v_mov_b32 v119, 0
    v_mfma_f32_16x16x16_bf16 v[44:47], v[26:27], v[10:11], 0
    s_nop 7
    v_cvt_pk_bf16_f32 v36, v44, v45
    v_cvt_pk_bf16_f32 v37, v46, v47
    v_and_b32 v38, v6, v36
    v_and_b32 v39, v6, v37
    s_nop 1
    v_mfma_f32_16x16x16_bf16 v[40:43], v[34:35], v[38:39], 0
    v_mfma_f32_16x16x16_bf16 v[84:87], v[10:11], v[36:37], v[40:43]
    v_mfma_f32_16x16x16_bf16 v[88:91], v[12:13], v[36:37], v[40:43]
    v_mfma_f32_16x16x16_bf16 v[92:95], v[14:15], v[36:37], v[40:43]
    v_mfma_f32_16x16x16_bf16 v[96:99], v[16:17], v[36:37], v[40:43]
    v_mfma_f32_16x16x16_bf16 v[100:103], v[18:19], v[36:37], v[40:43]
    v_mfma_f32_16x16x16_bf16 v[104:107], v[20:21], v[36:37], v[40:43]
    v_mfma_f32_16x16x16_bf16 v[108:111], v[22:23], v[36:37], v[40:43]
    v_mfma_f32_16x16x16_bf16 v[44:47], v[28:29], v[10:11], 0
    s_nop 0
    v_exp_f32 v84, v84
    v_exp_f32 v85, v85
    v_exp_f32 v86, v86
    v_exp_f32 v87, v87
    v_exp_f32 v88, v88
    v_exp_f32 v89, v89
    v_exp_f32 v90, v90
    v_exp_f32 v91, v91
    v_mfma_f32_16x16x16_bf16 v[48:51], v[30:31], v[10:11], 0
    v_cvt_pk_bf16_f32 v120, v44, v45
    v_cvt_pk_bf16_f32 v121, v46, v47
    v_and_b32 v38, v6, v120
    v_and_b32 v39, v6, v121
    s_nop 1
    v_mfma_f32_16x16x16_bf16 v[122:125], v[34:35], v[38:39], 0
    v_cvt_pk_bf16_f32 v84, v84, v85
    v_cvt_pk_bf16_f32 v85, v86, v87
    v_cvt_pk_bf16_f32 v86, v88, v89
    v_cvt_pk_bf16_f32 v87, v90, v91
    s_nop 1
    v_mfma_f32_16x16x32_bf16 v[52:55], v[58:61], v[84:87], 0
    v_exp_f32 v92, v92
    v_exp_f32 v93, v93
    v_exp_f32 v94, v94
    v_exp_f32 v95, v95
    v_exp_f32 v96, v96
    v_exp_f32 v97, v97
    v_exp_f32 v98, v98
    v_exp_f32 v99, v99
    v_cvt_pk_bf16_f32 v92, v92, v93
    v_cvt_pk_bf16_f32 v93, v94, v95
    v_cvt_pk_bf16_f32 v94, v96, v97
    v_cvt_pk_bf16_f32 v95, v98, v99
    s_nop 1
    v_mfma_f32_16x16x32_bf16 v[52:55], v[62:65], v[92:95], v[52:55]
    v_mfma_f32_16x16x16_bf16 v[84:87], v[10:11], v[120:121], v[122:125]
    v_mfma_f32_16x16x16_bf16 v[88:91], v[12:13], v[120:121], v[122:125]
    v_exp_f32 v100, v100
    v_exp_f32 v101, v101
    v_exp_f32 v102, v102
    v_exp_f32 v103, v103
    v_exp_f32 v104, v104
    v_exp_f32 v105, v105
    v_exp_f32 v106, v106
    v_exp_f32 v107, v107
    v_cvt_pk_bf16_f32 v100, v100, v101
    v_cvt_pk_bf16_f32 v101, v102, v103
    v_cvt_pk_bf16_f32 v102, v104, v105
    v_cvt_pk_bf16_f32 v103, v106, v107
    s_nop 1
    v_mfma_f32_16x16x32_bf16 v[52:55], v[66:69], v[100:103], v[52:55]
    v_mfma_f32_16x16x16_bf16 v[92:95], v[14:15], v[120:121], v[122:125]
    v_mfma_f32_16x16x16_bf16 v[96:99], v[16:17], v[120:121], v[122:125]
    v_exp_f32 v108, v108
    s_nop 0
    v_cvt_pk_bf16_f32 v116, v108, 0
    s_nop 1
    v_mfma_f32_16x16x32_bf16 v[52:55], v[56:59], v[116:119], v[52:55]
    v_mfma_f32_16x16x16_bf16 v[100:103], v[18:19], v[120:121], v[122:125]
    v_mfma_f32_16x16x16_bf16 v[104:107], v[20:21], v[120:121], v[122:125]
    v_mfma_f32_16x16x16_bf16 v[108:111], v[22:23], v[120:121], v[122:125]
    v_mfma_f32_16x16x16_bf16 v[44:47], v[26:27], v[12:13], 0
    v_exp_f32 v84, v84
    v_exp_f32 v85, v85
    v_exp_f32 v86, v86
    v_exp_f32 v87, v87
    v_exp_f32 v88, v88
    v_exp_f32 v89, v89
    v_exp_f32 v90, v90
    v_exp_f32 v91, v91
    v_rcp_f32 v112, v54
    v_cmp_gt_f32 vcc, 0x21800000, v54
    s_or_b64 s[46:47], s[46:47], vcc
    v_fma_f32 v113, v52, v112, v48
    v_fma_f32 v114, v53, v112, v49
    v_cvt_pk_bf16_f32 v115, v113, v114
    v_pk_max_i16 v115, v115, v9
    buffer_store_dword v115, v2, s[20:23], 0 offen offset:0
    v_mfma_f32_16x16x16_bf16 v[48:51], v[32:33], v[10:11], 0
    v_cvt_pk_bf16_f32 v36, v44, v45
    v_cvt_pk_bf16_f32 v37, v46, v47
    v_and_b32 v38, v6, v36
    v_and_b32 v39, v6, v37
    s_nop 1
    v_mfma_f32_16x16x16_bf16 v[40:43], v[34:35], v[38:39], 0
    v_cvt_pk_bf16_f32 v84, v84, v85
    v_cvt_pk_bf16_f32 v85, v86, v87
    v_cvt_pk_bf16_f32 v86, v88, v89
    v_cvt_pk_bf16_f32 v87, v90, v91
    s_nop 1
    v_mfma_f32_16x16x32_bf16 v[52:55], v[72:75], v[84:87], 0
    v_exp_f32 v92, v92
    v_exp_f32 v93, v93
    v_exp_f32 v94, v94
    v_exp_f32 v95, v95
    v_exp_f32 v96, v96
    v_exp_f32 v97, v97
    v_exp_f32 v98, v98
    v_exp_f32 v99, v99
    v_cvt_pk_bf16_f32 v92, v92, v93
    v_cvt_pk_bf16_f32 v93, v94, v95
    v_cvt_pk_bf16_f32 v94, v96, v97
    v_cvt_pk_bf16_f32 v95, v98, v99
    s_nop 1
    v_mfma_f32_16x16x32_bf16 v[52:55], v[76:79], v[92:95], v[52:55]
    v_mfma_f32_16x16x16_bf16 v[84:87], v[10:11], v[36:37], v[40:43]
    v_mfma_f32_16x16x16_bf16 v[88:91], v[12:13], v[36:37], v[40:43]
    v_exp_f32 v100, v100
    v_exp_f32 v101, v101
    v_exp_f32 v102, v102
    v_exp_f32 v103, v103
    v_exp_f32 v104, v104
    v_exp_f32 v105, v105
    v_exp_f32 v106, v106
    v_exp_f32 v107, v107
    v_cvt_pk_bf16_f32 v100, v100, v101
    v_cvt_pk_bf16_f32 v101, v102, v103
    v_cvt_pk_bf16_f32 v102, v104, v105
    v_cvt_pk_bf16_f32 v103, v106, v107
    s_nop 1
    v_mfma_f32_16x16x32_bf16 v[52:55], v[80:83], v[100:103], v[52:55]
    v_mfma_f32_16x16x16_bf16 v[92:95], v[14:15], v[36:37], v[40:43]
    v_mfma_f32_16x16x16_bf16 v[96:99], v[16:17], v[36:37], v[40:43]
    v_exp_f32 v108, v108
    s_nop 0
    v_cvt_pk_bf16_f32 v116, v108, 0
    s_nop 1
    v_mfma_f32_16x16x32_bf16 v[52:55], v[70:73], v[116:119], v[52:55]
    v_mfma_f32_16x16x16_bf16 v[100:103], v[18:19], v[36:37], v[40:43]
    v_mfma_f32_16x16x16_bf16 v[104:107], v[20:21], v[36:37], v[40:43]
    v_mfma_f32_16x16x16_bf16 v[108:111], v[22:23], v[36:37], v[40:43]
    v_mfma_f32_16x16x16_bf16 v[44:47], v[28:29], v[12:13], 0
    v_exp_f32 v84, v84
    v_exp_f32 v85, v85
    v_exp_f32 v86, v86
    v_exp_f32 v87, v87
    v_exp_f32 v88, v88
    v_exp_f32 v89, v89
    v_exp_f32 v90, v90
    v_exp_f32 v91, v91
    v_rcp_f32 v112, v54
    v_cmp_gt_f32 vcc, 0x21800000, v54
    s_or_b64 s[46:47], s[46:47], vcc
    v_fma_f32 v113, v52, v112, v48
    v_fma_f32 v114, v53, v112, v49
    v_cvt_pk_bf16_f32 v115, v113, v114
    v_pk_max_i16 v115, v115, v9
    buffer_store_dword v115, v2, s[20:23], 0 offen offset:16
    v_mfma_f32_16x16x16_bf16 v[48:51], v[30:31], v[12:13], 0
    v_cvt_pk_bf16_f32 v120, v44, v45
    v_cvt_pk_bf16_f32 v121, v46, v47
    v_and_b32 v38, v6, v120
    v_and_b32 v39, v6, v121
    s_nop 1
    v_mfma_f32_16x16x16_bf16 v[122:125], v[34:35], v[38:39], 0
    v_cvt_pk_bf16_f32 v84, v84, v85
    v_cvt_pk_bf16_f32 v85, v86, v87
    v_cvt_pk_bf16_f32 v86, v88, v89
    v_cvt_pk_bf16_f32 v87, v90, v91
    s_nop 1
    v_mfma_f32_16x16x32_bf16 v[52:55], v[58:61], v[84:87], 0
    v_exp_f32 v92, v92
    v_exp_f32 v93, v93
    v_exp_f32 v94, v94
    v_exp_f32 v95, v95
    v_exp_f32 v96, v96
    v_exp_f32 v97, v97
    v_exp_f32 v98, v98
    v_exp_f32 v99, v99
    v_cvt_pk_bf16_f32 v92, v92, v93
    v_cvt_pk_bf16_f32 v93, v94, v95
    v_cvt_pk_bf16_f32 v94, v96, v97
    v_cvt_pk_bf16_f32 v95, v98, v99
    s_nop 1
    v_mfma_f32_16x16x32_bf16 v[52:55], v[62:65], v[92:95], v[52:55]
    v_mfma_f32_16x16x16_bf16 v[84:87], v[10:11], v[120:121], v[122:125]
    v_mfma_f32_16x16x16_bf16 v[88:91], v[12:13], v[120:121], v[122:125]
    v_exp_f32 v100, v100
    v_exp_f32 v101, v101
    v_exp_f32 v102, v102
    v_exp_f32 v103, v103
    v_exp_f32 v104, v104
    v_exp_f32 v105, v105
    v_exp_f32 v106, v106
    v_exp_f32 v107, v107
    v_cvt_pk_bf16_f32 v100, v100, v101
    v_cvt_pk_bf16_f32 v101, v102, v103
    v_cvt_pk_bf16_f32 v102, v104, v105
    v_cvt_pk_bf16_f32 v103, v106, v107
    s_nop 1
    v_mfma_f32_16x16x32_bf16 v[52:55], v[66:69], v[100:103], v[52:55]
    v_mfma_f32_16x16x16_bf16 v[92:95], v[14:15], v[120:121], v[122:125]
    v_mfma_f32_16x16x16_bf16 v[96:99], v[16:17], v[120:121], v[122:125]
    v_exp_f32 v108, v108
    s_nop 0
    v_cvt_pk_bf16_f32 v116, v108, 0
    s_nop 1
    v_mfma_f32_16x16x32_bf16 v[52:55], v[56:59], v[116:119], v[52:55]
    v_mfma_f32_16x16x16_bf16 v[100:103], v[18:19], v[120:121], v[122:125]
    v_mfma_f32_16x16x16_bf16 v[104:107], v[20:21], v[120:121], v[122:125]
    v_mfma_f32_16x16x16_bf16 v[108:111], v[22:23], v[120:121], v[122:125]
    v_mfma_f32_16x16x16_bf16 v[44:47], v[26:27], v[14:15], 0
    v_exp_f32 v84, v84
    v_exp_f32 v85, v85
    v_exp_f32 v86, v86
    v_exp_f32 v87, v87
    v_exp_f32 v88, v88
    v_exp_f32 v89, v89
    v_exp_f32 v90, v90
    v_exp_f32 v91, v91
    v_rcp_f32 v112, v54
    v_cmp_gt_f32 vcc, 0x21800000, v54
    s_or_b64 s[46:47], s[46:47], vcc
    v_fma_f32 v113, v52, v112, v48
    v_fma_f32 v114, v53, v112, v49
    v_cvt_pk_bf16_f32 v115, v113, v114
    v_pk_max_i16 v115, v115, v9
    buffer_store_dword v115, v2, s[20:23], 0 offen offset:512
    v_mfma_f32_16x16x16_bf16 v[48:51], v[32:33], v[12:13], 0
    v_cvt_pk_bf16_f32 v36, v44, v45
    v_cvt_pk_bf16_f32 v37, v46, v47
    v_and_b32 v38, v6, v36
    v_and_b32 v39, v6, v37
    s_nop 1
    v_mfma_f32_16x16x16_bf16 v[40:43], v[34:35], v[38:39], 0
    v_cvt_pk_bf16_f32 v84, v84, v85
    v_cvt_pk_bf16_f32 v85, v86, v87
    v_cvt_pk_bf16_f32 v86, v88, v89
    v_cvt_pk_bf16_f32 v87, v90, v91
    s_nop 1
    v_mfma_f32_16x16x32_bf16 v[52:55], v[72:75], v[84:87], 0
    v_exp_f32 v92, v92
    v_exp_f32 v93, v93
    v_exp_f32 v94, v94
    v_exp_f32 v95, v95
    v_exp_f32 v96, v96
    v_exp_f32 v97, v97
    v_exp_f32 v98, v98
    v_exp_f32 v99, v99
    v_cvt_pk_bf16_f32 v92, v92, v93
    v_cvt_pk_bf16_f32 v93, v94, v95
    v_cvt_pk_bf16_f32 v94, v96, v97
    v_cvt_pk_bf16_f32 v95, v98, v99
    s_nop 1
    v_mfma_f32_16x16x32_bf16 v[52:55], v[76:79], v[92:95], v[52:55]
    v_mfma_f32_16x16x16_bf16 v[84:87], v[10:11], v[36:37], v[40:43]
    v_mfma_f32_16x16x16_bf16 v[88:91], v[12:13], v[36:37], v[40:43]
    v_exp_f32 v100, v100
    v_exp_f32 v101, v101
    v_exp_f32 v102, v102
    v_exp_f32 v103, v103
    v_exp_f32 v104, v104
    v_exp_f32 v105, v105
    v_exp_f32 v106, v106
    v_exp_f32 v107, v107
    v_cvt_pk_bf16_f32 v100, v100, v101
    v_cvt_pk_bf16_f32 v101, v102, v103
    v_cvt_pk_bf16_f32 v102, v104, v105
    v_cvt_pk_bf16_f32 v103, v106, v107
    s_nop 1
    v_mfma_f32_16x16x32_bf16 v[52:55], v[80:83], v[100:103], v[52:55]
    v_mfma_f32_16x16x16_bf16 v[92:95], v[14:15], v[36:37], v[40:43]
    v_mfma_f32_16x16x16_bf16 v[96:99], v[16:17], v[36:37], v[40:43]
    v_exp_f32 v108, v108
    s_nop 0
    v_cvt_pk_bf16_f32 v116, v108, 0
    s_nop 1
    v_mfma_f32_16x16x32_bf16 v[52:55], v[70:73], v[116:119], v[52:55]
    v_mfma_f32_16x16x16_bf16 v[100:103], v[18:19], v[36:37], v[40:43]
    v_mfma_f32_16x16x16_bf16 v[104:107], v[20:21], v[36:37], v[40:43]
    v_mfma_f32_16x16x16_bf16 v[108:111], v[22:23], v[36:37], v[40:43]
    v_mfma_f32_16x16x16_bf16 v[44:47], v[28:29], v[14:15], 0
    v_exp_f32 v84, v84
    v_exp_f32 v85, v85
    v_exp_f32 v86, v86
    v_exp_f32 v87, v87
    v_exp_f32 v88, v88
    v_exp_f32 v89, v89
    v_exp_f32 v90, v90
    v_exp_f32 v91, v91
    v_rcp_f32 v112, v54
    v_cmp_gt_f32 vcc, 0x21800000, v54
    s_or_b64 s[46:47], s[46:47], vcc
    v_fma_f32 v113, v52, v112, v48
    v_fma_f32 v114, v53, v112, v49
    v_cvt_pk_bf16_f32 v115, v113, v114
    v_pk_max_i16 v115, v115, v9
    buffer_store_dword v115, v2, s[20:23], 0 offen offset:528
    v_mfma_f32_16x16x16_bf16 v[48:51], v[30:31], v[14:15], 0
    v_cvt_pk_bf16_f32 v120, v44, v45
    v_cvt_pk_bf16_f32 v121, v46, v47
    v_and_b32 v38, v6, v120
    v_and_b32 v39, v6, v121
    s_nop 1
    v_mfma_f32_16x16x16_bf16 v[122:125], v[34:35], v[38:39], 0
    v_cvt_pk_bf16_f32 v84, v84, v85
    v_cvt_pk_bf16_f32 v85, v86, v87
    v_cvt_pk_bf16_f32 v86, v88, v89
    v_cvt_pk_bf16_f32 v87, v90, v91
    s_nop 1
    v_mfma_f32_16x16x32_bf16 v[52:55], v[58:61], v[84:87], 0
    v_exp_f32 v92, v92
    v_exp_f32 v93, v93
    v_exp_f32 v94, v94
    v_exp_f32 v95, v95
    v_exp_f32 v96, v96
    v_exp_f32 v97, v97
    v_exp_f32 v98, v98
    v_exp_f32 v99, v99
    v_cvt_pk_bf16_f32 v92, v92, v93
    v_cvt_pk_bf16_f32 v93, v94, v95
    v_cvt_pk_bf16_f32 v94, v96, v97
    v_cvt_pk_bf16_f32 v95, v98, v99
    s_nop 1
    v_mfma_f32_16x16x32_bf16 v[52:55], v[62:65], v[92:95], v[52:55]
    v_mfma_f32_16x16x16_bf16 v[84:87], v[10:11], v[120:121], v[122:125]
    v_mfma_f32_16x16x16_bf16 v[88:91], v[12:13], v[120:121], v[122:125]
    v_exp_f32 v100, v100
    v_exp_f32 v101, v101
    v_exp_f32 v102, v102
    v_exp_f32 v103, v103
    v_exp_f32 v104, v104
    v_exp_f32 v105, v105
    v_exp_f32 v106, v106
    v_exp_f32 v107, v107
    v_cvt_pk_bf16_f32 v100, v100, v101
    v_cvt_pk_bf16_f32 v101, v102, v103
    v_cvt_pk_bf16_f32 v102, v104, v105
    v_cvt_pk_bf16_f32 v103, v106, v107
    s_nop 1
    v_mfma_f32_16x16x32_bf16 v[52:55], v[66:69], v[100:103], v[52:55]
    v_mfma_f32_16x16x16_bf16 v[92:95], v[14:15], v[120:121], v[122:125]
    v_mfma_f32_16x16x16_bf16 v[96:99], v[16:17], v[120:121], v[122:125]
    v_exp_f32 v108, v108
    s_nop 0
    v_cvt_pk_bf16_f32 v116, v108, 0
    s_nop 1
    v_mfma_f32_16x16x32_bf16 v[52:55], v[56:59], v[116:119], v[52:55]
    v_mfma_f32_16x16x16_bf16 v[100:103], v[18:19], v[120:121], v[122:125]
    v_mfma_f32_16x16x16_bf16 v[104:107], v[20:21], v[120:121], v[122:125]
    v_mfma_f32_16x16x16_bf16 v[108:111], v[22:23], v[120:121], v[122:125]
    v_mfma_f32_16x16x16_bf16 v[44:47], v[26:27], v[16:17], 0
    v_exp_f32 v84, v84
    v_exp_f32 v85, v85
    v_exp_f32 v86, v86
    v_exp_f32 v87, v87
    v_exp_f32 v88, v88
    v_exp_f32 v89, v89
    v_exp_f32 v90, v90
    v_exp_f32 v91, v91
    v_rcp_f32 v112, v54
    v_cmp_gt_f32 vcc, 0x21800000, v54
    s_or_b64 s[46:47], s[46:47], vcc
    v_fma_f32 v113, v52, v112, v48
    v_fma_f32 v114, v53, v112, v49
    v_cvt_pk_bf16_f32 v115, v113, v114
    v_pk_max_i16 v115, v115, v9
    buffer_store_dword v115, v2, s[20:23], 0 offen offset:1024
    v_mfma_f32_16x16x16_bf16 v[48:51], v[32:33], v[14:15], 0
    v_cvt_pk_bf16_f32 v36, v44, v45
    v_cvt_pk_bf16_f32 v37, v46, v47
    v_and_b32 v38, v6, v36
    v_and_b32 v39, v6, v37
    s_nop 1
    v_mfma_f32_16x16x16_bf16 v[40:43], v[34:35], v[38:39], 0
    v_cvt_pk_bf16_f32 v84, v84, v85
    v_cvt_pk_bf16_f32 v85, v86, v87
    v_cvt_pk_bf16_f32 v86, v88, v89
    v_cvt_pk_bf16_f32 v87, v90, v91
    s_nop 1
    v_mfma_f32_16x16x32_bf16 v[52:55], v[72:75], v[84:87], 0
    v_exp_f32 v92, v92
    v_exp_f32 v93, v93
    v_exp_f32 v94, v94
    v_exp_f32 v95, v95
    v_exp_f32 v96, v96
    v_exp_f32 v97, v97
    v_exp_f32 v98, v98
    v_exp_f32 v99, v99
    v_cvt_pk_bf16_f32 v92, v92, v93
    v_cvt_pk_bf16_f32 v93, v94, v95
    v_cvt_pk_bf16_f32 v94, v96, v97
    v_cvt_pk_bf16_f32 v95, v98, v99
    s_nop 1
    v_mfma_f32_16x16x32_bf16 v[52:55], v[76:79], v[92:95], v[52:55]
    v_mfma_f32_16x16x16_bf16 v[84:87], v[10:11], v[36:37], v[40:43]
    v_mfma_f32_16x16x16_bf16 v[88:91], v[12:13], v[36:37], v[40:43]
    v_exp_f32 v100, v100
    v_exp_f32 v101, v101
    v_exp_f32 v102, v102
    v_exp_f32 v103, v103
    v_exp_f32 v104, v104
    v_exp_f32 v105, v105
    v_exp_f32 v106, v106
    v_exp_f32 v107, v107
    v_cvt_pk_bf16_f32 v100, v100, v101
    v_cvt_pk_bf16_f32 v101, v102, v103
    v_cvt_pk_bf16_f32 v102, v104, v105
    v_cvt_pk_bf16_f32 v103, v106, v107
    s_nop 1
    v_mfma_f32_16x16x32_bf16 v[52:55], v[80:83], v[100:103], v[52:55]
    v_mfma_f32_16x16x16_bf16 v[92:95], v[14:15], v[36:37], v[40:43]
    v_mfma_f32_16x16x16_bf16 v[96:99], v[16:17], v[36:37], v[40:43]
    v_exp_f32 v108, v108
    s_nop 0
    v_cvt_pk_bf16_f32 v116, v108, 0
    s_nop 1
    v_mfma_f32_16x16x32_bf16 v[52:55], v[70:73], v[116:119], v[52:55]
    v_mfma_f32_16x16x16_bf16 v[100:103], v[18:19], v[36:37], v[40:43]
    v_mfma_f32_16x16x16_bf16 v[104:107], v[20:21], v[36:37], v[40:43]
    v_mfma_f32_16x16x16_bf16 v[108:111], v[22:23], v[36:37], v[40:43]
    v_mfma_f32_16x16x16_bf16 v[44:47], v[28:29], v[16:17], 0
    v_exp_f32 v84, v84
    v_exp_f32 v85, v85
    v_exp_f32 v86, v86
    v_exp_f32 v87, v87
    v_exp_f32 v88, v88
    v_exp_f32 v89, v89
    v_exp_f32 v90, v90
    v_exp_f32 v91, v91
    v_rcp_f32 v112, v54
    v_cmp_gt_f32 vcc, 0x21800000, v54
    s_or_b64 s[46:47], s[46:47], vcc
    v_fma_f32 v113, v52, v112, v48
    v_fma_f32 v114, v53, v112, v49
    v_cvt_pk_bf16_f32 v115, v113, v114
    v_pk_max_i16 v115, v115, v9
    buffer_store_dword v115, v2, s[20:23], 0 offen offset:1040
    v_mfma_f32_16x16x16_bf16 v[48:51], v[30:31], v[16:17], 0
    v_cvt_pk_bf16_f32 v120, v44, v45
    v_cvt_pk_bf16_f32 v121, v46, v47
    v_and_b32 v38, v6, v120
    v_and_b32 v39, v6, v121
    s_nop 1
    v_mfma_f32_16x16x16_bf16 v[122:125], v[34:35], v[38:39], 0
    v_cvt_pk_bf16_f32 v84, v84, v85
    v_cvt_pk_bf16_f32 v85, v86, v87
    v_cvt_pk_bf16_f32 v86, v88, v89
    v_cvt_pk_bf16_f32 v87, v90, v91
    s_nop 1
    v_mfma_f32_16x16x32_bf16 v[52:55], v[58:61], v[84:87], 0
    v_exp_f32 v92, v92
    v_exp_f32 v93, v93
    v_exp_f32 v94, v94
    v_exp_f32 v95, v95
    v_exp_f32 v96, v96
    v_exp_f32 v97, v97
    v_exp_f32 v98, v98
    v_exp_f32 v99, v99
    v_cvt_pk_bf16_f32 v92, v92, v93
    v_cvt_pk_bf16_f32 v93, v94, v95
    v_cvt_pk_bf16_f32 v94, v96, v97
    v_cvt_pk_bf16_f32 v95, v98, v99
    s_nop 1
    v_mfma_f32_16x16x32_bf16 v[52:55], v[62:65], v[92:95], v[52:55]
    v_mfma_f32_16x16x16_bf16 v[84:87], v[10:11], v[120:121], v[122:125]
    v_mfma_f32_16x16x16_bf16 v[88:91], v[12:13], v[120:121], v[122:125]
    v_exp_f32 v100, v100
    v_exp_f32 v101, v101
    v_exp_f32 v102, v102
    v_exp_f32 v103, v103
    v_exp_f32 v104, v104
    v_exp_f32 v105, v105
    v_exp_f32 v106, v106
    v_exp_f32 v107, v107
    v_cvt_pk_bf16_f32 v100, v100, v101
    v_cvt_pk_bf16_f32 v101, v102, v103
    v_cvt_pk_bf16_f32 v102, v104, v105
    v_cvt_pk_bf16_f32 v103, v106, v107
    s_nop 1
    v_mfma_f32_16x16x32_bf16 v[52:55], v[66:69], v[100:103], v[52:55]
    v_mfma_f32_16x16x16_bf16 v[92:95], v[14:15], v[120:121], v[122:125]
    v_mfma_f32_16x16x16_bf16 v[96:99], v[16:17], v[120:121], v[122:125]
    v_exp_f32 v108, v108
    s_nop 0
    v_cvt_pk_bf16_f32 v116, v108, 0
    s_nop 1
    v_mfma_f32_16x16x32_bf16 v[52:55], v[56:59], v[116:119], v[52:55]
    v_mfma_f32_16x16x16_bf16 v[100:103], v[18:19], v[120:121], v[122:125]
    v_mfma_f32_16x16x16_bf16 v[104:107], v[20:21], v[120:121], v[122:125]
    v_mfma_f32_16x16x16_bf16 v[108:111], v[22:23], v[120:121], v[122:125]
    v_mfma_f32_16x16x16_bf16 v[44:47], v[26:27], v[18:19], 0
    v_exp_f32 v84, v84
    v_exp_f32 v85, v85
    v_exp_f32 v86, v86
    v_exp_f32 v87, v87
    v_exp_f32 v88, v88
    v_exp_f32 v89, v89
    v_exp_f32 v90, v90
    v_exp_f32 v91, v91
    v_rcp_f32 v112, v54
    v_cmp_gt_f32 vcc, 0x21800000, v54
    s_or_b64 s[46:47], s[46:47], vcc
    v_fma_f32 v113, v52, v112, v48
    v_fma_f32 v114, v53, v112, v49
    v_cvt_pk_bf16_f32 v115, v113, v114
    v_pk_max_i16 v115, v115, v9
    buffer_store_dword v115, v2, s[20:23], 0 offen offset:1536
    v_mfma_f32_16x16x16_bf16 v[48:51], v[32:33], v[16:17], 0
    v_cvt_pk_bf16_f32 v36, v44, v45
    v_cvt_pk_bf16_f32 v37, v46, v47
    v_and_b32 v38, v6, v36
    v_and_b32 v39, v6, v37
    s_nop 1
    v_mfma_f32_16x16x16_bf16 v[40:43], v[34:35], v[38:39], 0
    v_cvt_pk_bf16_f32 v84, v84, v85
    v_cvt_pk_bf16_f32 v85, v86, v87
    v_cvt_pk_bf16_f32 v86, v88, v89
    v_cvt_pk_bf16_f32 v87, v90, v91
    s_nop 1
    v_mfma_f32_16x16x32_bf16 v[52:55], v[72:75], v[84:87], 0
    v_exp_f32 v92, v92
    v_exp_f32 v93, v93
    v_exp_f32 v94, v94
    v_exp_f32 v95, v95
    v_exp_f32 v96, v96
    v_exp_f32 v97, v97
    v_exp_f32 v98, v98
    v_exp_f32 v99, v99
    v_cvt_pk_bf16_f32 v92, v92, v93
    v_cvt_pk_bf16_f32 v93, v94, v95
    v_cvt_pk_bf16_f32 v94, v96, v97
    v_cvt_pk_bf16_f32 v95, v98, v99
    s_nop 1
    v_mfma_f32_16x16x32_bf16 v[52:55], v[76:79], v[92:95], v[52:55]
    v_mfma_f32_16x16x16_bf16 v[84:87], v[10:11], v[36:37], v[40:43]
    v_mfma_f32_16x16x16_bf16 v[88:91], v[12:13], v[36:37], v[40:43]
    v_exp_f32 v100, v100
    v_exp_f32 v101, v101
    v_exp_f32 v102, v102
    v_exp_f32 v103, v103
    v_exp_f32 v104, v104
    v_exp_f32 v105, v105
    v_exp_f32 v106, v106
    v_exp_f32 v107, v107
    v_cvt_pk_bf16_f32 v100, v100, v101
    v_cvt_pk_bf16_f32 v101, v102, v103
    v_cvt_pk_bf16_f32 v102, v104, v105
    v_cvt_pk_bf16_f32 v103, v106, v107
    s_nop 1
    v_mfma_f32_16x16x32_bf16 v[52:55], v[80:83], v[100:103], v[52:55]
    v_mfma_f32_16x16x16_bf16 v[92:95], v[14:15], v[36:37], v[40:43]
    v_mfma_f32_16x16x16_bf16 v[96:99], v[16:17], v[36:37], v[40:43]
    v_exp_f32 v108, v108
    s_nop 0
    v_cvt_pk_bf16_f32 v116, v108, 0
    s_nop 1
    v_mfma_f32_16x16x32_bf16 v[52:55], v[70:73], v[116:119], v[52:55]
    v_mfma_f32_16x16x16_bf16 v[100:103], v[18:19], v[36:37], v[40:43]
    v_mfma_f32_16x16x16_bf16 v[104:107], v[20:21], v[36:37], v[40:43]
    v_mfma_f32_16x16x16_bf16 v[108:111], v[22:23], v[36:37], v[40:43]
    v_mfma_f32_16x16x16_bf16 v[44:47], v[28:29], v[18:19], 0
    v_exp_f32 v84, v84
    v_exp_f32 v85, v85
    v_exp_f32 v86, v86
    v_exp_f32 v87, v87
    v_exp_f32 v88, v88
    v_exp_f32 v89, v89
    v_exp_f32 v90, v90
    v_exp_f32 v91, v91
    v_rcp_f32 v112, v54
    v_cmp_gt_f32 vcc, 0x21800000, v54
    s_or_b64 s[46:47], s[46:47], vcc
    v_fma_f32 v113, v52, v112, v48
    v_fma_f32 v114, v53, v112, v49
    v_cvt_pk_bf16_f32 v115, v113, v114
    v_pk_max_i16 v115, v115, v9
    buffer_store_dword v115, v2, s[20:23], 0 offen offset:1552
    v_mfma_f32_16x16x16_bf16 v[48:51], v[30:31], v[18:19], 0
    v_cvt_pk_bf16_f32 v120, v44, v45
    v_cvt_pk_bf16_f32 v121, v46, v47
    v_and_b32 v38, v6, v120
    v_and_b32 v39, v6, v121
    s_nop 1
    v_mfma_f32_16x16x16_bf16 v[122:125], v[34:35], v[38:39], 0
    v_cvt_pk_bf16_f32 v84, v84, v85
    v_cvt_pk_bf16_f32 v85, v86, v87
    v_cvt_pk_bf16_f32 v86, v88, v89
    v_cvt_pk_bf16_f32 v87, v90, v91
    s_nop 1
    v_mfma_f32_16x16x32_bf16 v[52:55], v[58:61], v[84:87], 0
    v_exp_f32 v92, v92
    v_exp_f32 v93, v93
    v_exp_f32 v94, v94
    v_exp_f32 v95, v95
    v_exp_f32 v96, v96
    v_exp_f32 v97, v97
    v_exp_f32 v98, v98
    v_exp_f32 v99, v99
    v_cvt_pk_bf16_f32 v92, v92, v93
    v_cvt_pk_bf16_f32 v93, v94, v95
    v_cvt_pk_bf16_f32 v94, v96, v97
    v_cvt_pk_bf16_f32 v95, v98, v99
    s_nop 1
    v_mfma_f32_16x16x32_bf16 v[52:55], v[62:65], v[92:95], v[52:55]
    v_mfma_f32_16x16x16_bf16 v[84:87], v[10:11], v[120:121], v[122:125]
    v_mfma_f32_16x16x16_bf16 v[88:91], v[12:13], v[120:121], v[122:125]
    v_exp_f32 v100, v100
    v_exp_f32 v101, v101
    v_exp_f32 v102, v102
    v_exp_f32 v103, v103
    v_exp_f32 v104, v104
    v_exp_f32 v105, v105
    v_exp_f32 v106, v106
    v_exp_f32 v107, v107
    v_cvt_pk_bf16_f32 v100, v100, v101
    v_cvt_pk_bf16_f32 v101, v102, v103
    v_cvt_pk_bf16_f32 v102, v104, v105
    v_cvt_pk_bf16_f32 v103, v106, v107
    s_nop 1
    v_mfma_f32_16x16x32_bf16 v[52:55], v[66:69], v[100:103], v[52:55]
    v_mfma_f32_16x16x16_bf16 v[92:95], v[14:15], v[120:121], v[122:125]
    v_mfma_f32_16x16x16_bf16 v[96:99], v[16:17], v[120:121], v[122:125]
    v_exp_f32 v108, v108
    s_nop 0
    v_cvt_pk_bf16_f32 v116, v108, 0
    s_nop 1
    v_mfma_f32_16x16x32_bf16 v[52:55], v[56:59], v[116:119], v[52:55]
    v_mfma_f32_16x16x16_bf16 v[100:103], v[18:19], v[120:121], v[122:125]
    v_mfma_f32_16x16x16_bf16 v[104:107], v[20:21], v[120:121], v[122:125]
    v_mfma_f32_16x16x16_bf16 v[108:111], v[22:23], v[120:121], v[122:125]
    v_mfma_f32_16x16x16_bf16 v[44:47], v[26:27], v[20:21], 0
    v_exp_f32 v84, v84
    v_exp_f32 v85, v85
    v_exp_f32 v86, v86
    v_exp_f32 v87, v87
    v_exp_f32 v88, v88
    v_exp_f32 v89, v89
    v_exp_f32 v90, v90
    v_exp_f32 v91, v91
    v_rcp_f32 v112, v54
    v_cmp_gt_f32 vcc, 0x21800000, v54
    s_or_b64 s[46:47], s[46:47], vcc
    v_fma_f32 v113, v52, v112, v48
    v_fma_f32 v114, v53, v112, v49
    v_cvt_pk_bf16_f32 v115, v113, v114
    v_pk_max_i16 v115, v115, v9
    buffer_store_dword v115, v2, s[20:23], 0 offen offset:2048
    v_mfma_f32_16x16x16_bf16 v[48:51], v[32:33], v[18:19], 0
    v_cvt_pk_bf16_f32 v36, v44, v45
    v_cvt_pk_bf16_f32 v37, v46, v47
    v_and_b32 v38, v6, v36
    v_and_b32 v39, v6, v37
    s_nop 1
    v_mfma_f32_16x16x16_bf16 v[40:43], v[34:35], v[38:39], 0
    v_cvt_pk_bf16_f32 v84, v84, v85
    v_cvt_pk_bf16_f32 v85, v86, v87
    v_cvt_pk_bf16_f32 v86, v88, v89
    v_cvt_pk_bf16_f32 v87, v90, v91
    s_nop 1
    v_mfma_f32_16x16x32_bf16 v[52:55], v[72:75], v[84:87], 0
    v_exp_f32 v92, v92
    v_exp_f32 v93, v93
    v_exp_f32 v94, v94
    v_exp_f32 v95, v95
    v_exp_f32 v96, v96
    v_exp_f32 v97, v97
    v_exp_f32 v98, v98
    v_exp_f32 v99, v99
    v_cvt_pk_bf16_f32 v92, v92, v93
    v_cvt_pk_bf16_f32 v93, v94, v95
    v_cvt_pk_bf16_f32 v94, v96, v97
    v_cvt_pk_bf16_f32 v95, v98, v99
    s_nop 1
    v_mfma_f32_16x16x32_bf16 v[52:55], v[76:79], v[92:95], v[52:55]
    v_mfma_f32_16x16x16_bf16 v[84:87], v[10:11], v[36:37], v[40:43]
    v_mfma_f32_16x16x16_bf16 v[88:91], v[12:13], v[36:37], v[40:43]
    v_exp_f32 v100, v100
    v_exp_f32 v101, v101
    v_exp_f32 v102, v102
    v_exp_f32 v103, v103
    v_exp_f32 v104, v104
    v_exp_f32 v105, v105
    v_exp_f32 v106, v106
    v_exp_f32 v107, v107
    v_cvt_pk_bf16_f32 v100, v100, v101
    v_cvt_pk_bf16_f32 v101, v102, v103
    v_cvt_pk_bf16_f32 v102, v104, v105
    v_cvt_pk_bf16_f32 v103, v106, v107
    s_nop 1
    v_mfma_f32_16x16x32_bf16 v[52:55], v[80:83], v[100:103], v[52:55]
    v_mfma_f32_16x16x16_bf16 v[92:95], v[14:15], v[36:37], v[40:43]
    v_mfma_f32_16x16x16_bf16 v[96:99], v[16:17], v[36:37], v[40:43]
    v_exp_f32 v108, v108
    s_nop 0
    v_cvt_pk_bf16_f32 v116, v108, 0
    s_nop 1
    v_mfma_f32_16x16x32_bf16 v[52:55], v[70:73], v[116:119], v[52:55]
    v_mfma_f32_16x16x16_bf16 v[100:103], v[18:19], v[36:37], v[40:43]
    v_mfma_f32_16x16x16_bf16 v[104:107], v[20:21], v[36:37], v[40:43]
    v_mfma_f32_16x16x16_bf16 v[108:111], v[22:23], v[36:37], v[40:43]
    v_mfma_f32_16x16x16_bf16 v[44:47], v[28:29], v[20:21], 0
    v_exp_f32 v84, v84
    v_exp_f32 v85, v85
    v_exp_f32 v86, v86
    v_exp_f32 v87, v87
    v_exp_f32 v88, v88
    v_exp_f32 v89, v89
    v_exp_f32 v90, v90
    v_exp_f32 v91, v91
    v_rcp_f32 v112, v54
    v_cmp_gt_f32 vcc, 0x21800000, v54
    s_or_b64 s[46:47], s[46:47], vcc
    v_fma_f32 v113, v52, v112, v48
    v_fma_f32 v114, v53, v112, v49
    v_cvt_pk_bf16_f32 v115, v113, v114
    v_pk_max_i16 v115, v115, v9
    buffer_store_dword v115, v2, s[20:23], 0 offen offset:2064
    v_mfma_f32_16x16x16_bf16 v[48:51], v[30:31], v[20:21], 0
    v_cvt_pk_bf16_f32 v120, v44, v45
    v_cvt_pk_bf16_f32 v121, v46, v47
    v_and_b32 v38, v6, v120
    v_and_b32 v39, v6, v121
    s_nop 1
    v_mfma_f32_16x16x16_bf16 v[122:125], v[34:35], v[38:39], 0
    v_cvt_pk_bf16_f32 v84, v84, v85
    v_cvt_pk_bf16_f32 v85, v86, v87
    v_cvt_pk_bf16_f32 v86, v88, v89
    v_cvt_pk_bf16_f32 v87, v90, v91
    s_nop 1
    v_mfma_f32_16x16x32_bf16 v[52:55], v[58:61], v[84:87], 0
    v_exp_f32 v92, v92
    v_exp_f32 v93, v93
    v_exp_f32 v94, v94
    v_exp_f32 v95, v95
    v_exp_f32 v96, v96
    v_exp_f32 v97, v97
    v_exp_f32 v98, v98
    v_exp_f32 v99, v99
    v_cvt_pk_bf16_f32 v92, v92, v93
    v_cvt_pk_bf16_f32 v93, v94, v95
    v_cvt_pk_bf16_f32 v94, v96, v97
    v_cvt_pk_bf16_f32 v95, v98, v99
    s_nop 1
    v_mfma_f32_16x16x32_bf16 v[52:55], v[62:65], v[92:95], v[52:55]
    v_mfma_f32_16x16x16_bf16 v[84:87], v[10:11], v[120:121], v[122:125]
    v_mfma_f32_16x16x16_bf16 v[88:91], v[12:13], v[120:121], v[122:125]
    v_exp_f32 v100, v100
    v_exp_f32 v101, v101
    v_exp_f32 v102, v102
    v_exp_f32 v103, v103
    v_exp_f32 v104, v104
    v_exp_f32 v105, v105
    v_exp_f32 v106, v106
    v_exp_f32 v107, v107
    v_cvt_pk_bf16_f32 v100, v100, v101
    v_cvt_pk_bf16_f32 v101, v102, v103
    v_cvt_pk_bf16_f32 v102, v104, v105
    v_cvt_pk_bf16_f32 v103, v106, v107
    s_nop 1
    v_mfma_f32_16x16x32_bf16 v[52:55], v[66:69], v[100:103], v[52:55]
    v_mfma_f32_16x16x16_bf16 v[92:95], v[14:15], v[120:121], v[122:125]
    v_mfma_f32_16x16x16_bf16 v[96:99], v[16:17], v[120:121], v[122:125]
    v_exp_f32 v108, v108
    s_nop 0
    v_cvt_pk_bf16_f32 v116, v108, 0
    s_nop 1
    v_mfma_f32_16x16x32_bf16 v[52:55], v[56:59], v[116:119], v[52:55]
    v_mfma_f32_16x16x16_bf16 v[100:103], v[18:19], v[120:121], v[122:125]
    v_mfma_f32_16x16x16_bf16 v[104:107], v[20:21], v[120:121], v[122:125]
    v_mfma_f32_16x16x16_bf16 v[108:111], v[22:23], v[120:121], v[122:125]
    v_mfma_f32_16x16x16_bf16 v[44:47], v[26:27], v[24:25], 0
    v_mfma_f32_16x16x16_bf16 v[40:43], v[28:29], v[24:25], 0
    v_exp_f32 v84, v84
    v_exp_f32 v85, v85
    v_exp_f32 v86, v86
    v_exp_f32 v87, v87
    v_exp_f32 v88, v88
    v_exp_f32 v89, v89
    v_exp_f32 v90, v90
    v_exp_f32 v91, v91
    v_rcp_f32 v112, v54
    v_cmp_gt_f32 vcc, 0x21800000, v54
    s_or_b64 s[46:47], s[46:47], vcc
    v_fma_f32 v113, v52, v112, v48
    v_fma_f32 v114, v53, v112, v49
    v_cvt_pk_bf16_f32 v115, v113, v114
    v_pk_max_i16 v115, v115, v9
    buffer_store_dword v115, v2, s[20:23], 0 offen offset:2560
    v_mfma_f32_16x16x16_bf16 v[48:51], v[32:33], v[20:21], 0
    v_cvt_pk_bf16_f32 v36, v44, v45
    v_cvt_pk_bf16_f32 v37, v46, v47
    v_cvt_pk_bf16_f32 v38, v40, v41
    v_cvt_pk_bf16_f32 v39, v42, v43
    v_cndmask_b32_e64 v36, v36, v38, s[48:49]
    v_cndmask_b32_e64 v37, v37, v39, s[48:49]
    v_and_b32 v38, v6, v36
    v_and_b32 v39, v6, v37
    s_nop 1
    v_mfma_f32_16x16x16_bf16 v[40:43], v[34:35], v[38:39], 0
    v_cvt_pk_bf16_f32 v84, v84, v85
    v_cvt_pk_bf16_f32 v85, v86, v87
    v_cvt_pk_bf16_f32 v86, v88, v89
    v_cvt_pk_bf16_f32 v87, v90, v91
    s_nop 1
    v_mfma_f32_16x16x32_bf16 v[52:55], v[72:75], v[84:87], 0
    v_exp_f32 v92, v92
    v_exp_f32 v93, v93
    v_exp_f32 v94, v94
    v_exp_f32 v95, v95
    v_exp_f32 v96, v96
    v_exp_f32 v97, v97
    v_exp_f32 v98, v98
    v_exp_f32 v99, v99
    v_cvt_pk_bf16_f32 v92, v92, v93
    v_cvt_pk_bf16_f32 v93, v94, v95
    v_cvt_pk_bf16_f32 v94, v96, v97
    v_cvt_pk_bf16_f32 v95, v98, v99
    s_nop 1
    v_mfma_f32_16x16x32_bf16 v[52:55], v[76:79], v[92:95], v[52:55]
    v_mfma_f32_16x16x16_bf16 v[84:87], v[10:11], v[36:37], v[40:43]
    v_mfma_f32_16x16x16_bf16 v[88:91], v[12:13], v[36:37], v[40:43]
    v_exp_f32 v100, v100
    v_exp_f32 v101, v101
    v_exp_f32 v102, v102
    v_exp_f32 v103, v103
    v_exp_f32 v104, v104
    v_exp_f32 v105, v105
    v_exp_f32 v106, v106
    v_exp_f32 v107, v107
    v_cvt_pk_bf16_f32 v100, v100, v101
    v_cvt_pk_bf16_f32 v101, v102, v103
    v_cvt_pk_bf16_f32 v102, v104, v105
    v_cvt_pk_bf16_f32 v103, v106, v107
    s_nop 1
    v_mfma_f32_16x16x32_bf16 v[52:55], v[80:83], v[100:103], v[52:55]
    v_mfma_f32_16x16x16_bf16 v[92:95], v[14:15], v[36:37], v[40:43]
    v_mfma_f32_16x16x16_bf16 v[96:99], v[16:17], v[36:37], v[40:43]
    v_exp_f32 v108, v108
    s_nop 0
    v_cvt_pk_bf16_f32 v116, v108, 0
    s_nop 1
    v_mfma_f32_16x16x32_bf16 v[52:55], v[70:73], v[116:119], v[52:55]
    v_mfma_f32_16x16x16_bf16 v[100:103], v[18:19], v[36:37], v[40:43]
    v_mfma_f32_16x16x16_bf16 v[104:107], v[20:21], v[36:37], v[40:43]
    v_mfma_f32_16x16x16_bf16 v[108:111], v[22:23], v[36:37], v[40:43]
    v_exp_f32 v84, v84
    v_exp_f32 v85, v85
    v_exp_f32 v86, v86
    v_exp_f32 v87, v87
    v_exp_f32 v88, v88
    v_exp_f32 v89, v89
    v_exp_f32 v90, v90
    v_exp_f32 v91, v91
    v_rcp_f32 v112, v54
    v_cmp_gt_f32 vcc, 0x21800000, v54
    s_or_b64 s[46:47], s[46:47], vcc
    v_fma_f32 v113, v52, v112, v48
    v_fma_f32 v114, v53, v112, v49
    v_cvt_pk_bf16_f32 v115, v113, v114
    v_pk_max_i16 v115, v115, v9
    buffer_store_dword v115, v2, s[20:23], 0 offen offset:2576
    v_mfma_f32_16x16x16_bf16 v[48:51], v[30:31], v[24:25], 0
    v_cvt_pk_bf16_f32 v84, v84, v85
    v_cvt_pk_bf16_f32 v85, v86, v87
    v_cvt_pk_bf16_f32 v86, v88, v89
    v_cvt_pk_bf16_f32 v87, v90, v91
    s_nop 1
    v_mfma_f32_16x16x32_bf16 v[52:55], v[58:61], v[84:87], 0
    v_exp_f32 v92, v92
    v_exp_f32 v93, v93
    v_exp_f32 v94, v94
    v_exp_f32 v95, v95
    v_exp_f32 v96, v96
    v_exp_f32 v97, v97
    v_exp_f32 v98, v98
    v_exp_f32 v99, v99
    v_cvt_pk_bf16_f32 v92, v92, v93
    v_cvt_pk_bf16_f32 v93, v94, v95
    v_cvt_pk_bf16_f32 v94, v96, v97
    v_cvt_pk_bf16_f32 v95, v98, v99
    s_nop 1
    v_mfma_f32_16x16x32_bf16 v[52:55], v[62:65], v[92:95], v[52:55]
    v_exp_f32 v100, v100
    v_exp_f32 v101, v101
    v_exp_f32 v102, v102
    v_exp_f32 v103, v103
    v_exp_f32 v104, v104
    v_exp_f32 v105, v105
    v_exp_f32 v106, v106
    v_exp_f32 v107, v107
    v_cvt_pk_bf16_f32 v100, v100, v101
    v_cvt_pk_bf16_f32 v101, v102, v103
    v_cvt_pk_bf16_f32 v102, v104, v105
    v_cvt_pk_bf16_f32 v103, v106, v107
    s_nop 1
    v_mfma_f32_16x16x32_bf16 v[52:55], v[66:69], v[100:103], v[52:55]
    v_exp_f32 v108, v108
    s_nop 0
    v_cvt_pk_bf16_f32 v116, v108, 0
    s_nop 1
    v_mfma_f32_16x16x32_bf16 v[52:55], v[56:59], v[116:119], v[52:55]
    s_nop 7
    v_rcp_f32 v112, v54
    v_cmp_gt_f32 vcc, 0x21800000, v54
    s_or_b64 s[46:47], s[46:47], vcc
    v_fma_f32 v113, v52, v112, v48
    v_fma_f32 v114, v53, v112, v49
    v_cvt_pk_bf16_f32 v115, v113, v114
    v_pk_max_i16 v115, v115, v9
    buffer_store_dword v115, v3, s[20:23], 0 offen offset:0
    v_mfma_f32_16x16x16_bf16 v[48:51], v[32:33], v[24:25], 0
    v_mfma_f32_16x16x32_bf16 v[52:55], v[72:75], v[84:87], 0
    v_mfma_f32_16x16x32_bf16 v[52:55], v[76:79], v[92:95], v[52:55]
    v_mfma_f32_16x16x32_bf16 v[52:55], v[80:83], v[100:103], v[52:55]
    v_mfma_f32_16x16x32_bf16 v[52:55], v[70:73], v[116:119], v[52:55]
    s_nop 7
    v_rcp_f32 v112, v54
    v_cmp_gt_f32 vcc, 0x21800000, v54
    s_or_b64 s[46:47], s[46:47], vcc
    v_fma_f32 v113, v52, v112, v48
    v_fma_f32 v114, v53, v112, v49
    v_cvt_pk_bf16_f32 v115, v113, v114
    v_pk_max_i16 v115, v115, v9
    buffer_store_dword v115, v4, s[20:23], 0 offen offset:16
    s_cmp_eq_u64 s[46:47], 0
    s_cbranch_scc1 L_end
    s_nop 7
    v_mfma_f32_16x16x16_bf16 v[44:47], v[26:27], v[10:11], 0
    v_mfma_f32_16x16x16_bf16 v[48:51], v[30:31], v[10:11], 0
    s_nop 6
    v_cvt_pk_bf16_f32 v36, v44, v45
    v_cvt_pk_bf16_f32 v37, v46, v47
    s_nop 1
    v_mfma_f32_16x16x16_bf16 v[84:87], v[10:11], v[36:37], 0
    v_mfma_f32_16x16x16_bf16 v[88:91], v[12:13], v[36:37], 0
    v_mfma_f32_16x16x16_bf16 v[92:95], v[14:15], v[36:37], 0
    v_mfma_f32_16x16x16_bf16 v[96:99], v[16:17], v[36:37], 0
    v_mfma_f32_16x16x16_bf16 v[100:103], v[18:19], v[36:37], 0
    v_mfma_f32_16x16x16_bf16 v[104:107], v[20:21], v[36:37], 0
    v_mfma_f32_16x16x16_bf16 v[108:111], v[22:23], v[36:37], 0
    s_nop 1
    v_max3_f32 v112, v84, v85, v86
    v_max3_f32 v112, v112, v87, v88
    v_max3_f32 v112, v112, v89, v90
    v_max3_f32 v112, v112, v91, v92
    v_max3_f32 v112, v112, v93, v94
    v_max3_f32 v112, v112, v95, v96
    v_max3_f32 v112, v112, v97, v98
    v_max3_f32 v112, v112, v99, v100
    v_max3_f32 v112, v112, v101, v102
    v_max3_f32 v112, v112, v103, v104
    v_max3_f32 v112, v112, v105, v106
    v_max3_f32 v112, v112, v107, v108
    v_mov_b32 v113, v112
    s_nop 1
    v_permlane32_swap_b32 v112, v113
    v_max_f32 v112, v112, v113
    v_mov_b32 v113, v112
    s_nop 1
    v_permlane16_swap_b32 v112, v113
    v_max_f32 v112, v112, v113
    v_mul_f32 v40, -1.0, v112
    v_mul_f32 v41, -1.0, v112
    v_mul_f32 v42, -1.0, v112
    v_mul_f32 v43, -1.0, v112
    s_nop 1
    v_mfma_f32_16x16x16_bf16 v[84:87], v[10:11], v[36:37], v[40:43]
    v_mfma_f32_16x16x16_bf16 v[88:91], v[12:13], v[36:37], v[40:43]
    v_mfma_f32_16x16x16_bf16 v[92:95], v[14:15], v[36:37], v[40:43]
    v_mfma_f32_16x16x16_bf16 v[96:99], v[16:17], v[36:37], v[40:43]
    v_mfma_f32_16x16x16_bf16 v[100:103], v[18:19], v[36:37], v[40:43]
    v_mfma_f32_16x16x16_bf16 v[104:107], v[20:21], v[36:37], v[40:43]
    v_mfma_f32_16x16x16_bf16 v[108:111], v[22:23], v[36:37], v[40:43]
    s_nop 1
    v_exp_f32 v84, v84
    v_exp_f32 v85, v85
    v_exp_f32 v86, v86
    v_exp_f32 v87, v87
    v_exp_f32 v88, v88
    v_exp_f32 v89, v89
    v_exp_f32 v90, v90
    v_exp_f32 v91, v91
    v_cvt_pk_bf16_f32 v84, v84, v85
    v_cvt_pk_bf16_f32 v85, v86, v87
    v_cvt_pk_bf16_f32 v86, v88, v89
    v_cvt_pk_bf16_f32 v87, v90, v91
    v_exp_f32 v92, v92
    v_exp_f32 v93, v93
    v_exp_f32 v94, v94
    v_exp_f32 v95, v95
    v_exp_f32 v96, v96
    v_exp_f32 v97, v97
    v_exp_f32 v98, v98
    v_exp_f32 v99, v99
    v_cvt_pk_bf16_f32 v92, v92, v93
    v_cvt_pk_bf16_f32 v93, v94, v95
    v_cvt_pk_bf16_f32 v94, v96, v97
    v_cvt_pk_bf16_f32 v95, v98, v99
    v_exp_f32 v100, v100
    v_exp_f32 v101, v101
    v_exp_f32 v102, v102
    v_exp_f32 v103, v103
    v_exp_f32 v104, v104
    v_exp_f32 v105, v105
    v_exp_f32 v106, v106
    v_exp_f32 v107, v107
    v_cvt_pk_bf16_f32 v100, v100, v101
    v_cvt_pk_bf16_f32 v101, v102, v103
    v_cvt_pk_bf16_f32 v102, v104, v105
    v_cvt_pk_bf16_f32 v103, v106, v107
    v_exp_f32 v108, v108
    s_nop 0
    v_cvt_pk_bf16_f32 v116, v108, 0
    v_mfma_f32_16x16x32_bf16 v[52:55], v[58:61], v[84:87], 0
    v_mfma_f32_16x16x32_bf16 v[52:55], v[62:65], v[92:95], v[52:55]
    v_mfma_f32_16x16x32_bf16 v[52:55], v[66:69], v[100:103], v[52:55]
    v_mfma_f32_16x16x32_bf16 v[52:55], v[56:59], v[116:119], v[52:55]
    s_nop 7
    v_rcp_f32 v112, v54
    s_nop 0
    v_fma_f32 v113, v52, v112, v48
    v_fma_f32 v114, v53, v112, v49
    v_cvt_pk_bf16_f32 v115, v113, v114
    v_pk_max_i16 v115, v115, v9
    buffer_store_dword v115, v2, s[20:23], 0 offen offset:0
    v_mfma_f32_16x16x16_bf16 v[44:47], v[28:29], v[10:11], 0
    v_mfma_f32_16x16x16_bf16 v[48:51], v[32:33], v[10:11], 0
    s_nop 6
    v_cvt_pk_bf16_f32 v36, v44, v45
    v_cvt_pk_bf16_f32 v37, v46, v47
    s_nop 1
    v_mfma_f32_16x16x16_bf16 v[84:87], v[10:11], v[36:37], 0
    v_mfma_f32_16x16x16_bf16 v[88:91], v[12:13], v[36:37], 0
    v_mfma_f32_16x16x16_bf16 v[92:95], v[14:15], v[36:37], 0
    v_mfma_f32_16x16x16_bf16 v[96:99], v[16:17], v[36:37], 0
    v_mfma_f32_16x16x16_bf16 v[100:103], v[18:19], v[36:37], 0
    v_mfma_f32_16x16x16_bf16 v[104:107], v[20:21], v[36:37], 0
    v_mfma_f32_16x16x16_bf16 v[108:111], v[22:23], v[36:37], 0
    s_nop 1
    v_max3_f32 v112, v84, v85, v86
    v_max3_f32 v112, v112, v87, v88
    v_max3_f32 v112, v112, v89, v90
    v_max3_f32 v112, v112, v91, v92
    v_max3_f32 v112, v112, v93, v94
    v_max3_f32 v112, v112, v95, v96
    v_max3_f32 v112, v112, v97, v98
    v_max3_f32 v112, v112, v99, v100
    v_max3_f32 v112, v112, v101, v102
    v_max3_f32 v112, v112, v103, v104
    v_max3_f32 v112, v112, v105, v106
    v_max3_f32 v112, v112, v107, v108
    v_mov_b32 v113, v112
    s_nop 1
    v_permlane32_swap_b32 v112, v113
    v_max_f32 v112, v112, v113
    v_mov_b32 v113, v112
    s_nop 1
    v_permlane16_swap_b32 v112, v113
    v_max_f32 v112, v112, v113
    v_mul_f32 v40, -1.0, v112
    v_mul_f32 v41, -1.0, v112
    v_mul_f32 v42, -1.0, v112
    v_mul_f32 v43, -1.0, v112
    s_nop 1
    v_mfma_f32_16x16x16_bf16 v[84:87], v[10:11], v[36:37], v[40:43]
    v_mfma_f32_16x16x16_bf16 v[88:91], v[12:13], v[36:37], v[40:43]
    v_mfma_f32_16x16x16_bf16 v[92:95], v[14:15], v[36:37], v[40:43]
    v_mfma_f32_16x16x16_bf16 v[96:99], v[16:17], v[36:37], v[40:43]
    v_mfma_f32_16x16x16_bf16 v[100:103], v[18:19], v[36:37], v[40:43]
    v_mfma_f32_16x16x16_bf16 v[104:107], v[20:21], v[36:37], v[40:43]
    v_mfma_f32_16x16x16_bf16 v[108:111], v[22:23], v[36:37], v[40:43]
    s_nop 1
    v_exp_f32 v84, v84
    v_exp_f32 v85, v85
    v_exp_f32 v86, v86
    v_exp_f32 v87, v87
    v_exp_f32 v88, v88
    v_exp_f32 v89, v89
    v_exp_f32 v90, v90
    v_exp_f32 v91, v91
    v_cvt_pk_bf16_f32 v84, v84, v85
    v_cvt_pk_bf16_f32 v85, v86, v87
    v_cvt_pk_bf16_f32 v86, v88, v89
    v_cvt_pk_bf16_f32 v87, v90, v91
    v_exp_f32 v92, v92
    v_exp_f32 v93, v93
    v_exp_f32 v94, v94
    v_exp_f32 v95, v95
    v_exp_f32 v96, v96
    v_exp_f32 v97, v97
    v_exp_f32 v98, v98
    v_exp_f32 v99, v99
    v_cvt_pk_bf16_f32 v92, v92, v93
    v_cvt_pk_bf16_f32 v93, v94, v95
    v_cvt_pk_bf16_f32 v94, v96, v97
    v_cvt_pk_bf16_f32 v95, v98, v99
    v_exp_f32 v100, v100
    v_exp_f32 v101, v101
    v_exp_f32 v102, v102
    v_exp_f32 v103, v103
    v_exp_f32 v104, v104
    v_exp_f32 v105, v105
    v_exp_f32 v106, v106
    v_exp_f32 v107, v107
    v_cvt_pk_bf16_f32 v100, v100, v101
    v_cvt_pk_bf16_f32 v101, v102, v103
    v_cvt_pk_bf16_f32 v102, v104, v105
    v_cvt_pk_bf16_f32 v103, v106, v107
    v_exp_f32 v108, v108
    s_nop 0
    v_cvt_pk_bf16_f32 v116, v108, 0
    v_mfma_f32_16x16x32_bf16 v[52:55], v[72:75], v[84:87], 0
    v_mfma_f32_16x16x32_bf16 v[52:55], v[76:79], v[92:95], v[52:55]
    v_mfma_f32_16x16x32_bf16 v[52:55], v[80:83], v[100:103], v[52:55]
    v_mfma_f32_16x16x32_bf16 v[52:55], v[70:73], v[116:119], v[52:55]
    s_nop 7
    v_rcp_f32 v112, v54
    s_nop 0
    v_fma_f32 v113, v52, v112, v48
    v_fma_f32 v114, v53, v112, v49
    v_cvt_pk_bf16_f32 v115, v113, v114
    v_pk_max_i16 v115, v115, v9
    buffer_store_dword v115, v2, s[20:23], 0 offen offset:16
    v_mfma_f32_16x16x16_bf16 v[44:47], v[26:27], v[12:13], 0
    v_mfma_f32_16x16x16_bf16 v[48:51], v[30:31], v[12:13], 0
    s_nop 6
    v_cvt_pk_bf16_f32 v36, v44, v45
    v_cvt_pk_bf16_f32 v37, v46, v47
    s_nop 1
    v_mfma_f32_16x16x16_bf16 v[84:87], v[10:11], v[36:37], 0
    v_mfma_f32_16x16x16_bf16 v[88:91], v[12:13], v[36:37], 0
    v_mfma_f32_16x16x16_bf16 v[92:95], v[14:15], v[36:37], 0
    v_mfma_f32_16x16x16_bf16 v[96:99], v[16:17], v[36:37], 0
    v_mfma_f32_16x16x16_bf16 v[100:103], v[18:19], v[36:37], 0
    v_mfma_f32_16x16x16_bf16 v[104:107], v[20:21], v[36:37], 0
    v_mfma_f32_16x16x16_bf16 v[108:111], v[22:23], v[36:37], 0
    s_nop 1
    v_max3_f32 v112, v84, v85, v86
    v_max3_f32 v112, v112, v87, v88
    v_max3_f32 v112, v112, v89, v90
    v_max3_f32 v112, v112, v91, v92
    v_max3_f32 v112, v112, v93, v94
    v_max3_f32 v112, v112, v95, v96
    v_max3_f32 v112, v112, v97, v98
    v_max3_f32 v112, v112, v99, v100
    v_max3_f32 v112, v112, v101, v102
    v_max3_f32 v112, v112, v103, v104
    v_max3_f32 v112, v112, v105, v106
    v_max3_f32 v112, v112, v107, v108
    v_mov_b32 v113, v112
    s_nop 1
    v_permlane32_swap_b32 v112, v113
    v_max_f32 v112, v112, v113
    v_mov_b32 v113, v112
    s_nop 1
    v_permlane16_swap_b32 v112, v113
    v_max_f32 v112, v112, v113
    v_mul_f32 v40, -1.0, v112
    v_mul_f32 v41, -1.0, v112
    v_mul_f32 v42, -1.0, v112
    v_mul_f32 v43, -1.0, v112
    s_nop 1
    v_mfma_f32_16x16x16_bf16 v[84:87], v[10:11], v[36:37], v[40:43]
    v_mfma_f32_16x16x16_bf16 v[88:91], v[12:13], v[36:37], v[40:43]
    v_mfma_f32_16x16x16_bf16 v[92:95], v[14:15], v[36:37], v[40:43]
    v_mfma_f32_16x16x16_bf16 v[96:99], v[16:17], v[36:37], v[40:43]
    v_mfma_f32_16x16x16_bf16 v[100:103], v[18:19], v[36:37], v[40:43]
    v_mfma_f32_16x16x16_bf16 v[104:107], v[20:21], v[36:37], v[40:43]
    v_mfma_f32_16x16x16_bf16 v[108:111], v[22:23], v[36:37], v[40:43]
    s_nop 1
    v_exp_f32 v84, v84
    v_exp_f32 v85, v85
    v_exp_f32 v86, v86
    v_exp_f32 v87, v87
    v_exp_f32 v88, v88
    v_exp_f32 v89, v89
    v_exp_f32 v90, v90
    v_exp_f32 v91, v91
    v_cvt_pk_bf16_f32 v84, v84, v85
    v_cvt_pk_bf16_f32 v85, v86, v87
    v_cvt_pk_bf16_f32 v86, v88, v89
    v_cvt_pk_bf16_f32 v87, v90, v91
    v_exp_f32 v92, v92
    v_exp_f32 v93, v93
    v_exp_f32 v94, v94
    v_exp_f32 v95, v95
    v_exp_f32 v96, v96
    v_exp_f32 v97, v97
    v_exp_f32 v98, v98
    v_exp_f32 v99, v99
    v_cvt_pk_bf16_f32 v92, v92, v93
    v_cvt_pk_bf16_f32 v93, v94, v95
    v_cvt_pk_bf16_f32 v94, v96, v97
    v_cvt_pk_bf16_f32 v95, v98, v99
    v_exp_f32 v100, v100
    v_exp_f32 v101, v101
    v_exp_f32 v102, v102
    v_exp_f32 v103, v103
    v_exp_f32 v104, v104
    v_exp_f32 v105, v105
    v_exp_f32 v106, v106
    v_exp_f32 v107, v107
    v_cvt_pk_bf16_f32 v100, v100, v101
    v_cvt_pk_bf16_f32 v101, v102, v103
    v_cvt_pk_bf16_f32 v102, v104, v105
    v_cvt_pk_bf16_f32 v103, v106, v107
    v_exp_f32 v108, v108
    s_nop 0
    v_cvt_pk_bf16_f32 v116, v108, 0
    v_mfma_f32_16x16x32_bf16 v[52:55], v[58:61], v[84:87], 0
    v_mfma_f32_16x16x32_bf16 v[52:55], v[62:65], v[92:95], v[52:55]
    v_mfma_f32_16x16x32_bf16 v[52:55], v[66:69], v[100:103], v[52:55]
    v_mfma_f32_16x16x32_bf16 v[52:55], v[56:59], v[116:119], v[52:55]
    s_nop 7
    v_rcp_f32 v112, v54
    s_nop 0
    v_fma_f32 v113, v52, v112, v48
    v_fma_f32 v114, v53, v112, v49
    v_cvt_pk_bf16_f32 v115, v113, v114
    v_pk_max_i16 v115, v115, v9
    buffer_store_dword v115, v2, s[20:23], 0 offen offset:512
    v_mfma_f32_16x16x16_bf16 v[44:47], v[28:29], v[12:13], 0
    v_mfma_f32_16x16x16_bf16 v[48:51], v[32:33], v[12:13], 0
    s_nop 6
    v_cvt_pk_bf16_f32 v36, v44, v45
    v_cvt_pk_bf16_f32 v37, v46, v47
    s_nop 1
    v_mfma_f32_16x16x16_bf16 v[84:87], v[10:11], v[36:37], 0
    v_mfma_f32_16x16x16_bf16 v[88:91], v[12:13], v[36:37], 0
    v_mfma_f32_16x16x16_bf16 v[92:95], v[14:15], v[36:37], 0
    v_mfma_f32_16x16x16_bf16 v[96:99], v[16:17], v[36:37], 0
    v_mfma_f32_16x16x16_bf16 v[100:103], v[18:19], v[36:37], 0
    v_mfma_f32_16x16x16_bf16 v[104:107], v[20:21], v[36:37], 0
    v_mfma_f32_16x16x16_bf16 v[108:111], v[22:23], v[36:37], 0
    s_nop 1
    v_max3_f32 v112, v84, v85, v86
    v_max3_f32 v112, v112, v87, v88
    v_max3_f32 v112, v112, v89, v90
    v_max3_f32 v112, v112, v91, v92
    v_max3_f32 v112, v112, v93, v94
    v_max3_f32 v112, v112, v95, v96
    v_max3_f32 v112, v112, v97, v98
    v_max3_f32 v112, v112, v99, v100
    v_max3_f32 v112, v112, v101, v102
    v_max3_f32 v112, v112, v103, v104
    v_max3_f32 v112, v112, v105, v106
    v_max3_f32 v112, v112, v107, v108
    v_mov_b32 v113, v112
    s_nop 1
    v_permlane32_swap_b32 v112, v113
    v_max_f32 v112, v112, v113
    v_mov_b32 v113, v112
    s_nop 1
    v_permlane16_swap_b32 v112, v113
    v_max_f32 v112, v112, v113
    v_mul_f32 v40, -1.0, v112
    v_mul_f32 v41, -1.0, v112
    v_mul_f32 v42, -1.0, v112
    v_mul_f32 v43, -1.0, v112
    s_nop 1
    v_mfma_f32_16x16x16_bf16 v[84:87], v[10:11], v[36:37], v[40:43]
    v_mfma_f32_16x16x16_bf16 v[88:91], v[12:13], v[36:37], v[40:43]
    v_mfma_f32_16x16x16_bf16 v[92:95], v[14:15], v[36:37], v[40:43]
    v_mfma_f32_16x16x16_bf16 v[96:99], v[16:17], v[36:37], v[40:43]
    v_mfma_f32_16x16x16_bf16 v[100:103], v[18:19], v[36:37], v[40:43]
    v_mfma_f32_16x16x16_bf16 v[104:107], v[20:21], v[36:37], v[40:43]
    v_mfma_f32_16x16x16_bf16 v[108:111], v[22:23], v[36:37], v[40:43]
    s_nop 1
    v_exp_f32 v84, v84
    v_exp_f32 v85, v85
    v_exp_f32 v86, v86
    v_exp_f32 v87, v87
    v_exp_f32 v88, v88
    v_exp_f32 v89, v89
    v_exp_f32 v90, v90
    v_exp_f32 v91, v91
    v_cvt_pk_bf16_f32 v84, v84, v85
    v_cvt_pk_bf16_f32 v85, v86, v87
    v_cvt_pk_bf16_f32 v86, v88, v89
    v_cvt_pk_bf16_f32 v87, v90, v91
    v_exp_f32 v92, v92
    v_exp_f32 v93, v93
    v_exp_f32 v94, v94
    v_exp_f32 v95, v95
    v_exp_f32 v96, v96
    v_exp_f32 v97, v97
    v_exp_f32 v98, v98
    v_exp_f32 v99, v99
    v_cvt_pk_bf16_f32 v92, v92, v93
    v_cvt_pk_bf16_f32 v93, v94, v95
    v_cvt_pk_bf16_f32 v94, v96, v97
    v_cvt_pk_bf16_f32 v95, v98, v99
    v_exp_f32 v100, v100
    v_exp_f32 v101, v101
    v_exp_f32 v102, v102
    v_exp_f32 v103, v103
    v_exp_f32 v104, v104
    v_exp_f32 v105, v105
    v_exp_f32 v106, v106
    v_exp_f32 v107, v107
    v_cvt_pk_bf16_f32 v100, v100, v101
    v_cvt_pk_bf16_f32 v101, v102, v103
    v_cvt_pk_bf16_f32 v102, v104, v105
    v_cvt_pk_bf16_f32 v103, v106, v107
    v_exp_f32 v108, v108
    s_nop 0
    v_cvt_pk_bf16_f32 v116, v108, 0
    v_mfma_f32_16x16x32_bf16 v[52:55], v[72:75], v[84:87], 0
    v_mfma_f32_16x16x32_bf16 v[52:55], v[76:79], v[92:95], v[52:55]
    v_mfma_f32_16x16x32_bf16 v[52:55], v[80:83], v[100:103], v[52:55]
    v_mfma_f32_16x16x32_bf16 v[52:55], v[70:73], v[116:119], v[52:55]
    s_nop 7
    v_rcp_f32 v112, v54
    s_nop 0
    v_fma_f32 v113, v52, v112, v48
    v_fma_f32 v114, v53, v112, v49
    v_cvt_pk_bf16_f32 v115, v113, v114
    v_pk_max_i16 v115, v115, v9
    buffer_store_dword v115, v2, s[20:23], 0 offen offset:528
    v_mfma_f32_16x16x16_bf16 v[44:47], v[26:27], v[14:15], 0
    v_mfma_f32_16x16x16_bf16 v[48:51], v[30:31], v[14:15], 0
    s_nop 6
    v_cvt_pk_bf16_f32 v36, v44, v45
    v_cvt_pk_bf16_f32 v37, v46, v47
    s_nop 1
    v_mfma_f32_16x16x16_bf16 v[84:87], v[10:11], v[36:37], 0
    v_mfma_f32_16x16x16_bf16 v[88:91], v[12:13], v[36:37], 0
    v_mfma_f32_16x16x16_bf16 v[92:95], v[14:15], v[36:37], 0
    v_mfma_f32_16x16x16_bf16 v[96:99], v[16:17], v[36:37], 0
    v_mfma_f32_16x16x16_bf16 v[100:103], v[18:19], v[36:37], 0
    v_mfma_f32_16x16x16_bf16 v[104:107], v[20:21], v[36:37], 0
    v_mfma_f32_16x16x16_bf16 v[108:111], v[22:23], v[36:37], 0
    s_nop 1
    v_max3_f32 v112, v84, v85, v86
    v_max3_f32 v112, v112, v87, v88
    v_max3_f32 v112, v112, v89, v90
    v_max3_f32 v112, v112, v91, v92
    v_max3_f32 v112, v112, v93, v94
    v_max3_f32 v112, v112, v95, v96
    v_max3_f32 v112, v112, v97, v98
    v_max3_f32 v112, v112, v99, v100
    v_max3_f32 v112, v112, v101, v102
    v_max3_f32 v112, v112, v103, v104
    v_max3_f32 v112, v112, v105, v106
    v_max3_f32 v112, v112, v107, v108
    v_mov_b32 v113, v112
    s_nop 1
    v_permlane32_swap_b32 v112, v113
    v_max_f32 v112, v112, v113
    v_mov_b32 v113, v112
    s_nop 1
    v_permlane16_swap_b32 v112, v113
    v_max_f32 v112, v112, v113
    v_mul_f32 v40, -1.0, v112
    v_mul_f32 v41, -1.0, v112
    v_mul_f32 v42, -1.0, v112
    v_mul_f32 v43, -1.0, v112
    s_nop 1
    v_mfma_f32_16x16x16_bf16 v[84:87], v[10:11], v[36:37], v[40:43]
    v_mfma_f32_16x16x16_bf16 v[88:91], v[12:13], v[36:37], v[40:43]
    v_mfma_f32_16x16x16_bf16 v[92:95], v[14:15], v[36:37], v[40:43]
    v_mfma_f32_16x16x16_bf16 v[96:99], v[16:17], v[36:37], v[40:43]
    v_mfma_f32_16x16x16_bf16 v[100:103], v[18:19], v[36:37], v[40:43]
    v_mfma_f32_16x16x16_bf16 v[104:107], v[20:21], v[36:37], v[40:43]
    v_mfma_f32_16x16x16_bf16 v[108:111], v[22:23], v[36:37], v[40:43]
    s_nop 1
    v_exp_f32 v84, v84
    v_exp_f32 v85, v85
    v_exp_f32 v86, v86
    v_exp_f32 v87, v87
    v_exp_f32 v88, v88
    v_exp_f32 v89, v89
    v_exp_f32 v90, v90
    v_exp_f32 v91, v91
    v_cvt_pk_bf16_f32 v84, v84, v85
    v_cvt_pk_bf16_f32 v85, v86, v87
    v_cvt_pk_bf16_f32 v86, v88, v89
    v_cvt_pk_bf16_f32 v87, v90, v91
    v_exp_f32 v92, v92
    v_exp_f32 v93, v93
    v_exp_f32 v94, v94
    v_exp_f32 v95, v95
    v_exp_f32 v96, v96
    v_exp_f32 v97, v97
    v_exp_f32 v98, v98
    v_exp_f32 v99, v99
    v_cvt_pk_bf16_f32 v92, v92, v93
    v_cvt_pk_bf16_f32 v93, v94, v95
    v_cvt_pk_bf16_f32 v94, v96, v97
    v_cvt_pk_bf16_f32 v95, v98, v99
    v_exp_f32 v100, v100
    v_exp_f32 v101, v101
    v_exp_f32 v102, v102
    v_exp_f32 v103, v103
    v_exp_f32 v104, v104
    v_exp_f32 v105, v105
    v_exp_f32 v106, v106
    v_exp_f32 v107, v107
    v_cvt_pk_bf16_f32 v100, v100, v101
    v_cvt_pk_bf16_f32 v101, v102, v103
    v_cvt_pk_bf16_f32 v102, v104, v105
    v_cvt_pk_bf16_f32 v103, v106, v107
    v_exp_f32 v108, v108
    s_nop 0
    v_cvt_pk_bf16_f32 v116, v108, 0
    v_mfma_f32_16x16x32_bf16 v[52:55], v[58:61], v[84:87], 0
    v_mfma_f32_16x16x32_bf16 v[52:55], v[62:65], v[92:95], v[52:55]
    v_mfma_f32_16x16x32_bf16 v[52:55], v[66:69], v[100:103], v[52:55]
    v_mfma_f32_16x16x32_bf16 v[52:55], v[56:59], v[116:119], v[52:55]
    s_nop 7
    v_rcp_f32 v112, v54
    s_nop 0
    v_fma_f32 v113, v52, v112, v48
    v_fma_f32 v114, v53, v112, v49
    v_cvt_pk_bf16_f32 v115, v113, v114
    v_pk_max_i16 v115, v115, v9
    buffer_store_dword v115, v2, s[20:23], 0 offen offset:1024
    v_mfma_f32_16x16x16_bf16 v[44:47], v[28:29], v[14:15], 0
    v_mfma_f32_16x16x16_bf16 v[48:51], v[32:33], v[14:15], 0
    s_nop 6
    v_cvt_pk_bf16_f32 v36, v44, v45
    v_cvt_pk_bf16_f32 v37, v46, v47
    s_nop 1
    v_mfma_f32_16x16x16_bf16 v[84:87], v[10:11], v[36:37], 0
    v_mfma_f32_16x16x16_bf16 v[88:91], v[12:13], v[36:37], 0
    v_mfma_f32_16x16x16_bf16 v[92:95], v[14:15], v[36:37], 0
    v_mfma_f32_16x16x16_bf16 v[96:99], v[16:17], v[36:37], 0
    v_mfma_f32_16x16x16_bf16 v[100:103], v[18:19], v[36:37], 0
    v_mfma_f32_16x16x16_bf16 v[104:107], v[20:21], v[36:37], 0
    v_mfma_f32_16x16x16_bf16 v[108:111], v[22:23], v[36:37], 0
    s_nop 1
    v_max3_f32 v112, v84, v85, v86
    v_max3_f32 v112, v112, v87, v88
    v_max3_f32 v112, v112, v89, v90
    v_max3_f32 v112, v112, v91, v92
    v_max3_f32 v112, v112, v93, v94
    v_max3_f32 v112, v112, v95, v96
    v_max3_f32 v112, v112, v97, v98
    v_max3_f32 v112, v112, v99, v100
    v_max3_f32 v112, v112, v101, v102
    v_max3_f32 v112, v112, v103, v104
    v_max3_f32 v112, v112, v105, v106
    v_max3_f32 v112, v112, v107, v108
    v_mov_b32 v113, v112
    s_nop 1
    v_permlane32_swap_b32 v112, v113
    v_max_f32 v112, v112, v113
    v_mov_b32 v113, v112
    s_nop 1
    v_permlane16_swap_b32 v112, v113
    v_max_f32 v112, v112, v113
    v_mul_f32 v40, -1.0, v112
    v_mul_f32 v41, -1.0, v112
    v_mul_f32 v42, -1.0, v112
    v_mul_f32 v43, -1.0, v112
    s_nop 1
    v_mfma_f32_16x16x16_bf16 v[84:87], v[10:11], v[36:37], v[40:43]
    v_mfma_f32_16x16x16_bf16 v[88:91], v[12:13], v[36:37], v[40:43]
    v_mfma_f32_16x16x16_bf16 v[92:95], v[14:15], v[36:37], v[40:43]
    v_mfma_f32_16x16x16_bf16 v[96:99], v[16:17], v[36:37], v[40:43]
    v_mfma_f32_16x16x16_bf16 v[100:103], v[18:19], v[36:37], v[40:43]
    v_mfma_f32_16x16x16_bf16 v[104:107], v[20:21], v[36:37], v[40:43]
    v_mfma_f32_16x16x16_bf16 v[108:111], v[22:23], v[36:37], v[40:43]
    s_nop 1
    v_exp_f32 v84, v84
    v_exp_f32 v85, v85
    v_exp_f32 v86, v86
    v_exp_f32 v87, v87
    v_exp_f32 v88, v88
    v_exp_f32 v89, v89
    v_exp_f32 v90, v90
    v_exp_f32 v91, v91
    v_cvt_pk_bf16_f32 v84, v84, v85
    v_cvt_pk_bf16_f32 v85, v86, v87
    v_cvt_pk_bf16_f32 v86, v88, v89
    v_cvt_pk_bf16_f32 v87, v90, v91
    v_exp_f32 v92, v92
    v_exp_f32 v93, v93
    v_exp_f32 v94, v94
    v_exp_f32 v95, v95
    v_exp_f32 v96, v96
    v_exp_f32 v97, v97
    v_exp_f32 v98, v98
    v_exp_f32 v99, v99
    v_cvt_pk_bf16_f32 v92, v92, v93
    v_cvt_pk_bf16_f32 v93, v94, v95
    v_cvt_pk_bf16_f32 v94, v96, v97
    v_cvt_pk_bf16_f32 v95, v98, v99
    v_exp_f32 v100, v100
    v_exp_f32 v101, v101
    v_exp_f32 v102, v102
    v_exp_f32 v103, v103
    v_exp_f32 v104, v104
    v_exp_f32 v105, v105
    v_exp_f32 v106, v106
    v_exp_f32 v107, v107
    v_cvt_pk_bf16_f32 v100, v100, v101
    v_cvt_pk_bf16_f32 v101, v102, v103
    v_cvt_pk_bf16_f32 v102, v104, v105
    v_cvt_pk_bf16_f32 v103, v106, v107
    v_exp_f32 v108, v108
    s_nop 0
    v_cvt_pk_bf16_f32 v116, v108, 0
    v_mfma_f32_16x16x32_bf16 v[52:55], v[72:75], v[84:87], 0
    v_mfma_f32_16x16x32_bf16 v[52:55], v[76:79], v[92:95], v[52:55]
    v_mfma_f32_16x16x32_bf16 v[52:55], v[80:83], v[100:103], v[52:55]
    v_mfma_f32_16x16x32_bf16 v[52:55], v[70:73], v[116:119], v[52:55]
    s_nop 7
    v_rcp_f32 v112, v54
    s_nop 0
    v_fma_f32 v113, v52, v112, v48
    v_fma_f32 v114, v53, v112, v49
    v_cvt_pk_bf16_f32 v115, v113, v114
    v_pk_max_i16 v115, v115, v9
    buffer_store_dword v115, v2, s[20:23], 0 offen offset:1040
    v_mfma_f32_16x16x16_bf16 v[44:47], v[26:27], v[16:17], 0
    v_mfma_f32_16x16x16_bf16 v[48:51], v[30:31], v[16:17], 0
    s_nop 6
    v_cvt_pk_bf16_f32 v36, v44, v45
    v_cvt_pk_bf16_f32 v37, v46, v47
    s_nop 1
    v_mfma_f32_16x16x16_bf16 v[84:87], v[10:11], v[36:37], 0
    v_mfma_f32_16x16x16_bf16 v[88:91], v[12:13], v[36:37], 0
    v_mfma_f32_16x16x16_bf16 v[92:95], v[14:15], v[36:37], 0
    v_mfma_f32_16x16x16_bf16 v[96:99], v[16:17], v[36:37], 0
    v_mfma_f32_16x16x16_bf16 v[100:103], v[18:19], v[36:37], 0
    v_mfma_f32_16x16x16_bf16 v[104:107], v[20:21], v[36:37], 0
    v_mfma_f32_16x16x16_bf16 v[108:111], v[22:23], v[36:37], 0
    s_nop 1
    v_max3_f32 v112, v84, v85, v86
    v_max3_f32 v112, v112, v87, v88
    v_max3_f32 v112, v112, v89, v90
    v_max3_f32 v112, v112, v91, v92
    v_max3_f32 v112, v112, v93, v94
    v_max3_f32 v112, v112, v95, v96
    v_max3_f32 v112, v112, v97, v98
    v_max3_f32 v112, v112, v99, v100
    v_max3_f32 v112, v112, v101, v102
    v_max3_f32 v112, v112, v103, v104
    v_max3_f32 v112, v112, v105, v106
    v_max3_f32 v112, v112, v107, v108
    v_mov_b32 v113, v112
    s_nop 1
    v_permlane32_swap_b32 v112, v113
    v_max_f32 v112, v112, v113
    v_mov_b32 v113, v112
    s_nop 1
    v_permlane16_swap_b32 v112, v113
    v_max_f32 v112, v112, v113
    v_mul_f32 v40, -1.0, v112
    v_mul_f32 v41, -1.0, v112
    v_mul_f32 v42, -1.0, v112
    v_mul_f32 v43, -1.0, v112
    s_nop 1
    v_mfma_f32_16x16x16_bf16 v[84:87], v[10:11], v[36:37], v[40:43]
    v_mfma_f32_16x16x16_bf16 v[88:91], v[12:13], v[36:37], v[40:43]
    v_mfma_f32_16x16x16_bf16 v[92:95], v[14:15], v[36:37], v[40:43]
    v_mfma_f32_16x16x16_bf16 v[96:99], v[16:17], v[36:37], v[40:43]
    v_mfma_f32_16x16x16_bf16 v[100:103], v[18:19], v[36:37], v[40:43]
    v_mfma_f32_16x16x16_bf16 v[104:107], v[20:21], v[36:37], v[40:43]
    v_mfma_f32_16x16x16_bf16 v[108:111], v[22:23], v[36:37], v[40:43]
    s_nop 1
    v_exp_f32 v84, v84
    v_exp_f32 v85, v85
    v_exp_f32 v86, v86
    v_exp_f32 v87, v87
    v_exp_f32 v88, v88
    v_exp_f32 v89, v89
    v_exp_f32 v90, v90
    v_exp_f32 v91, v91
    v_cvt_pk_bf16_f32 v84, v84, v85
    v_cvt_pk_bf16_f32 v85, v86, v87
    v_cvt_pk_bf16_f32 v86, v88, v89
    v_cvt_pk_bf16_f32 v87, v90, v91
    v_exp_f32 v92, v92
    v_exp_f32 v93, v93
    v_exp_f32 v94, v94
    v_exp_f32 v95, v95
    v_exp_f32 v96, v96
    v_exp_f32 v97, v97
    v_exp_f32 v98, v98
    v_exp_f32 v99, v99
    v_cvt_pk_bf16_f32 v92, v92, v93
    v_cvt_pk_bf16_f32 v93, v94, v95
    v_cvt_pk_bf16_f32 v94, v96, v97
    v_cvt_pk_bf16_f32 v95, v98, v99
    v_exp_f32 v100, v100
    v_exp_f32 v101, v101
    v_exp_f32 v102, v102
    v_exp_f32 v103, v103
    v_exp_f32 v104, v104
    v_exp_f32 v105, v105
    v_exp_f32 v106, v106
    v_exp_f32 v107, v107
    v_cvt_pk_bf16_f32 v100, v100, v101
    v_cvt_pk_bf16_f32 v101, v102, v103
    v_cvt_pk_bf16_f32 v102, v104, v105
    v_cvt_pk_bf16_f32 v103, v106, v107
    v_exp_f32 v108, v108
    s_nop 0
    v_cvt_pk_bf16_f32 v116, v108, 0
    v_mfma_f32_16x16x32_bf16 v[52:55], v[58:61], v[84:87], 0
    v_mfma_f32_16x16x32_bf16 v[52:55], v[62:65], v[92:95], v[52:55]
    v_mfma_f32_16x16x32_bf16 v[52:55], v[66:69], v[100:103], v[52:55]
    v_mfma_f32_16x16x32_bf16 v[52:55], v[56:59], v[116:119], v[52:55]
    s_nop 7
    v_rcp_f32 v112, v54
    s_nop 0
    v_fma_f32 v113, v52, v112, v48
    v_fma_f32 v114, v53, v112, v49
    v_cvt_pk_bf16_f32 v115, v113, v114
    v_pk_max_i16 v115, v115, v9
    buffer_store_dword v115, v2, s[20:23], 0 offen offset:1536
    v_mfma_f32_16x16x16_bf16 v[44:47], v[28:29], v[16:17], 0
    v_mfma_f32_16x16x16_bf16 v[48:51], v[32:33], v[16:17], 0
    s_nop 6
    v_cvt_pk_bf16_f32 v36, v44, v45
    v_cvt_pk_bf16_f32 v37, v46, v47
    s_nop 1
    v_mfma_f32_16x16x16_bf16 v[84:87], v[10:11], v[36:37], 0
    v_mfma_f32_16x16x16_bf16 v[88:91], v[12:13], v[36:37], 0
    v_mfma_f32_16x16x16_bf16 v[92:95], v[14:15], v[36:37], 0
    v_mfma_f32_16x16x16_bf16 v[96:99], v[16:17], v[36:37], 0
    v_mfma_f32_16x16x16_bf16 v[100:103], v[18:19], v[36:37], 0
    v_mfma_f32_16x16x16_bf16 v[104:107], v[20:21], v[36:37], 0
    v_mfma_f32_16x16x16_bf16 v[108:111], v[22:23], v[36:37], 0
    s_nop 1
    v_max3_f32 v112, v84, v85, v86
    v_max3_f32 v112, v112, v87, v88
    v_max3_f32 v112, v112, v89, v90
    v_max3_f32 v112, v112, v91, v92
    v_max3_f32 v112, v112, v93, v94
    v_max3_f32 v112, v112, v95, v96
    v_max3_f32 v112, v112, v97, v98
    v_max3_f32 v112, v112, v99, v100
    v_max3_f32 v112, v112, v101, v102
    v_max3_f32 v112, v112, v103, v104
    v_max3_f32 v112, v112, v105, v106
    v_max3_f32 v112, v112, v107, v108
    v_mov_b32 v113, v112
    s_nop 1
    v_permlane32_swap_b32 v112, v113
    v_max_f32 v112, v112, v113
    v_mov_b32 v113, v112
    s_nop 1
    v_permlane16_swap_b32 v112, v113
    v_max_f32 v112, v112, v113
    v_mul_f32 v40, -1.0, v112
    v_mul_f32 v41, -1.0, v112
    v_mul_f32 v42, -1.0, v112
    v_mul_f32 v43, -1.0, v112
    s_nop 1
    v_mfma_f32_16x16x16_bf16 v[84:87], v[10:11], v[36:37], v[40:43]
    v_mfma_f32_16x16x16_bf16 v[88:91], v[12:13], v[36:37], v[40:43]
    v_mfma_f32_16x16x16_bf16 v[92:95], v[14:15], v[36:37], v[40:43]
    v_mfma_f32_16x16x16_bf16 v[96:99], v[16:17], v[36:37], v[40:43]
    v_mfma_f32_16x16x16_bf16 v[100:103], v[18:19], v[36:37], v[40:43]
    v_mfma_f32_16x16x16_bf16 v[104:107], v[20:21], v[36:37], v[40:43]
    v_mfma_f32_16x16x16_bf16 v[108:111], v[22:23], v[36:37], v[40:43]
    s_nop 1
    v_exp_f32 v84, v84
    v_exp_f32 v85, v85
    v_exp_f32 v86, v86
    v_exp_f32 v87, v87
    v_exp_f32 v88, v88
    v_exp_f32 v89, v89
    v_exp_f32 v90, v90
    v_exp_f32 v91, v91
    v_cvt_pk_bf16_f32 v84, v84, v85
    v_cvt_pk_bf16_f32 v85, v86, v87
    v_cvt_pk_bf16_f32 v86, v88, v89
    v_cvt_pk_bf16_f32 v87, v90, v91
    v_exp_f32 v92, v92
    v_exp_f32 v93, v93
    v_exp_f32 v94, v94
    v_exp_f32 v95, v95
    v_exp_f32 v96, v96
    v_exp_f32 v97, v97
    v_exp_f32 v98, v98
    v_exp_f32 v99, v99
    v_cvt_pk_bf16_f32 v92, v92, v93
    v_cvt_pk_bf16_f32 v93, v94, v95
    v_cvt_pk_bf16_f32 v94, v96, v97
    v_cvt_pk_bf16_f32 v95, v98, v99
    v_exp_f32 v100, v100
    v_exp_f32 v101, v101
    v_exp_f32 v102, v102
    v_exp_f32 v103, v103
    v_exp_f32 v104, v104
    v_exp_f32 v105, v105
    v_exp_f32 v106, v106
    v_exp_f32 v107, v107
    v_cvt_pk_bf16_f32 v100, v100, v101
    v_cvt_pk_bf16_f32 v101, v102, v103
    v_cvt_pk_bf16_f32 v102, v104, v105
    v_cvt_pk_bf16_f32 v103, v106, v107
    v_exp_f32 v108, v108
    s_nop 0
    v_cvt_pk_bf16_f32 v116, v108, 0
    v_mfma_f32_16x16x32_bf16 v[52:55], v[72:75], v[84:87], 0
    v_mfma_f32_16x16x32_bf16 v[52:55], v[76:79], v[92:95], v[52:55]
    v_mfma_f32_16x16x32_bf16 v[52:55], v[80:83], v[100:103], v[52:55]
    v_mfma_f32_16x16x32_bf16 v[52:55], v[70:73], v[116:119], v[52:55]
    s_nop 7
    v_rcp_f32 v112, v54
    s_nop 0
    v_fma_f32 v113, v52, v112, v48
    v_fma_f32 v114, v53, v112, v49
    v_cvt_pk_bf16_f32 v115, v113, v114
    v_pk_max_i16 v115, v115, v9
    buffer_store_dword v115, v2, s[20:23], 0 offen offset:1552
    v_mfma_f32_16x16x16_bf16 v[44:47], v[26:27], v[18:19], 0
    v_mfma_f32_16x16x16_bf16 v[48:51], v[30:31], v[18:19], 0
    s_nop 6
    v_cvt_pk_bf16_f32 v36, v44, v45
    v_cvt_pk_bf16_f32 v37, v46, v47
    s_nop 1
    v_mfma_f32_16x16x16_bf16 v[84:87], v[10:11], v[36:37], 0
    v_mfma_f32_16x16x16_bf16 v[88:91], v[12:13], v[36:37], 0
    v_mfma_f32_16x16x16_bf16 v[92:95], v[14:15], v[36:37], 0
    v_mfma_f32_16x16x16_bf16 v[96:99], v[16:17], v[36:37], 0
    v_mfma_f32_16x16x16_bf16 v[100:103], v[18:19], v[36:37], 0
    v_mfma_f32_16x16x16_bf16 v[104:107], v[20:21], v[36:37], 0
    v_mfma_f32_16x16x16_bf16 v[108:111], v[22:23], v[36:37], 0
    s_nop 1
    v_max3_f32 v112, v84, v85, v86
    v_max3_f32 v112, v112, v87, v88
    v_max3_f32 v112, v112, v89, v90
    v_max3_f32 v112, v112, v91, v92
    v_max3_f32 v112, v112, v93, v94
    v_max3_f32 v112, v112, v95, v96
    v_max3_f32 v112, v112, v97, v98
    v_max3_f32 v112, v112, v99, v100
    v_max3_f32 v112, v112, v101, v102
    v_max3_f32 v112, v112, v103, v104
    v_max3_f32 v112, v112, v105, v106
    v_max3_f32 v112, v112, v107, v108
    v_mov_b32 v113, v112
    s_nop 1
    v_permlane32_swap_b32 v112, v113
    v_max_f32 v112, v112, v113
    v_mov_b32 v113, v112
    s_nop 1
    v_permlane16_swap_b32 v112, v113
    v_max_f32 v112, v112, v113
    v_mul_f32 v40, -1.0, v112
    v_mul_f32 v41, -1.0, v112
    v_mul_f32 v42, -1.0, v112
    v_mul_f32 v43, -1.0, v112
    s_nop 1
    v_mfma_f32_16x16x16_bf16 v[84:87], v[10:11], v[36:37], v[40:43]
    v_mfma_f32_16x16x16_bf16 v[88:91], v[12:13], v[36:37], v[40:43]
    v_mfma_f32_16x16x16_bf16 v[92:95], v[14:15], v[36:37], v[40:43]
    v_mfma_f32_16x16x16_bf16 v[96:99], v[16:17], v[36:37], v[40:43]
    v_mfma_f32_16x16x16_bf16 v[100:103], v[18:19], v[36:37], v[40:43]
    v_mfma_f32_16x16x16_bf16 v[104:107], v[20:21], v[36:37], v[40:43]
    v_mfma_f32_16x16x16_bf16 v[108:111], v[22:23], v[36:37], v[40:43]
    s_nop 1
    v_exp_f32 v84, v84
    v_exp_f32 v85, v85
    v_exp_f32 v86, v86
    v_exp_f32 v87, v87
    v_exp_f32 v88, v88
    v_exp_f32 v89, v89
    v_exp_f32 v90, v90
    v_exp_f32 v91, v91
    v_cvt_pk_bf16_f32 v84, v84, v85
    v_cvt_pk_bf16_f32 v85, v86, v87
    v_cvt_pk_bf16_f32 v86, v88, v89
    v_cvt_pk_bf16_f32 v87, v90, v91
    v_exp_f32 v92, v92
    v_exp_f32 v93, v93
    v_exp_f32 v94, v94
    v_exp_f32 v95, v95
    v_exp_f32 v96, v96
    v_exp_f32 v97, v97
    v_exp_f32 v98, v98
    v_exp_f32 v99, v99
    v_cvt_pk_bf16_f32 v92, v92, v93
    v_cvt_pk_bf16_f32 v93, v94, v95
    v_cvt_pk_bf16_f32 v94, v96, v97
    v_cvt_pk_bf16_f32 v95, v98, v99
    v_exp_f32 v100, v100
    v_exp_f32 v101, v101
    v_exp_f32 v102, v102
    v_exp_f32 v103, v103
    v_exp_f32 v104, v104
    v_exp_f32 v105, v105
    v_exp_f32 v106, v106
    v_exp_f32 v107, v107
    v_cvt_pk_bf16_f32 v100, v100, v101
    v_cvt_pk_bf16_f32 v101, v102, v103
    v_cvt_pk_bf16_f32 v102, v104, v105
    v_cvt_pk_bf16_f32 v103, v106, v107
    v_exp_f32 v108, v108
    s_nop 0
    v_cvt_pk_bf16_f32 v116, v108, 0
    v_mfma_f32_16x16x32_bf16 v[52:55], v[58:61], v[84:87], 0
    v_mfma_f32_16x16x32_bf16 v[52:55], v[62:65], v[92:95], v[52:55]
    v_mfma_f32_16x16x32_bf16 v[52:55], v[66:69], v[100:103], v[52:55]
    v_mfma_f32_16x16x32_bf16 v[52:55], v[56:59], v[116:119], v[52:55]
    s_nop 7
    v_rcp_f32 v112, v54
    s_nop 0
    v_fma_f32 v113, v52, v112, v48
    v_fma_f32 v114, v53, v112, v49
    v_cvt_pk_bf16_f32 v115, v113, v114
    v_pk_max_i16 v115, v115, v9
    buffer_store_dword v115, v2, s[20:23], 0 offen offset:2048
    v_mfma_f32_16x16x16_bf16 v[44:47], v[28:29], v[18:19], 0
    v_mfma_f32_16x16x16_bf16 v[48:51], v[32:33], v[18:19], 0
    s_nop 6
    v_cvt_pk_bf16_f32 v36, v44, v45
    v_cvt_pk_bf16_f32 v37, v46, v47
    s_nop 1
    v_mfma_f32_16x16x16_bf16 v[84:87], v[10:11], v[36:37], 0
    v_mfma_f32_16x16x16_bf16 v[88:91], v[12:13], v[36:37], 0
    v_mfma_f32_16x16x16_bf16 v[92:95], v[14:15], v[36:37], 0
    v_mfma_f32_16x16x16_bf16 v[96:99], v[16:17], v[36:37], 0
    v_mfma_f32_16x16x16_bf16 v[100:103], v[18:19], v[36:37], 0
    v_mfma_f32_16x16x16_bf16 v[104:107], v[20:21], v[36:37], 0
    v_mfma_f32_16x16x16_bf16 v[108:111], v[22:23], v[36:37], 0
    s_nop 1
    v_max3_f32 v112, v84, v85, v86
    v_max3_f32 v112, v112, v87, v88
    v_max3_f32 v112, v112, v89, v90
    v_max3_f32 v112, v112, v91, v92
    v_max3_f32 v112, v112, v93, v94
    v_max3_f32 v112, v112, v95, v96
    v_max3_f32 v112, v112, v97, v98
    v_max3_f32 v112, v112, v99, v100
    v_max3_f32 v112, v112, v101, v102
    v_max3_f32 v112, v112, v103, v104
    v_max3_f32 v112, v112, v105, v106
    v_max3_f32 v112, v112, v107, v108
    v_mov_b32 v113, v112
    s_nop 1
    v_permlane32_swap_b32 v112, v113
    v_max_f32 v112, v112, v113
    v_mov_b32 v113, v112
    s_nop 1
    v_permlane16_swap_b32 v112, v113
    v_max_f32 v112, v112, v113
    v_mul_f32 v40, -1.0, v112
    v_mul_f32 v41, -1.0, v112
    v_mul_f32 v42, -1.0, v112
    v_mul_f32 v43, -1.0, v112
    s_nop 1
    v_mfma_f32_16x16x16_bf16 v[84:87], v[10:11], v[36:37], v[40:43]
    v_mfma_f32_16x16x16_bf16 v[88:91], v[12:13], v[36:37], v[40:43]
    v_mfma_f32_16x16x16_bf16 v[92:95], v[14:15], v[36:37], v[40:43]
    v_mfma_f32_16x16x16_bf16 v[96:99], v[16:17], v[36:37], v[40:43]
    v_mfma_f32_16x16x16_bf16 v[100:103], v[18:19], v[36:37], v[40:43]
    v_mfma_f32_16x16x16_bf16 v[104:107], v[20:21], v[36:37], v[40:43]
    v_mfma_f32_16x16x16_bf16 v[108:111], v[22:23], v[36:37], v[40:43]
    s_nop 1
    v_exp_f32 v84, v84
    v_exp_f32 v85, v85
    v_exp_f32 v86, v86
    v_exp_f32 v87, v87
    v_exp_f32 v88, v88
    v_exp_f32 v89, v89
    v_exp_f32 v90, v90
    v_exp_f32 v91, v91
    v_cvt_pk_bf16_f32 v84, v84, v85
    v_cvt_pk_bf16_f32 v85, v86, v87
    v_cvt_pk_bf16_f32 v86, v88, v89
    v_cvt_pk_bf16_f32 v87, v90, v91
    v_exp_f32 v92, v92
    v_exp_f32 v93, v93
    v_exp_f32 v94, v94
    v_exp_f32 v95, v95
    v_exp_f32 v96, v96
    v_exp_f32 v97, v97
    v_exp_f32 v98, v98
    v_exp_f32 v99, v99
    v_cvt_pk_bf16_f32 v92, v92, v93
    v_cvt_pk_bf16_f32 v93, v94, v95
    v_cvt_pk_bf16_f32 v94, v96, v97
    v_cvt_pk_bf16_f32 v95, v98, v99
    v_exp_f32 v100, v100
    v_exp_f32 v101, v101
    v_exp_f32 v102, v102
    v_exp_f32 v103, v103
    v_exp_f32 v104, v104
    v_exp_f32 v105, v105
    v_exp_f32 v106, v106
    v_exp_f32 v107, v107
    v_cvt_pk_bf16_f32 v100, v100, v101
    v_cvt_pk_bf16_f32 v101, v102, v103
    v_cvt_pk_bf16_f32 v102, v104, v105
    v_cvt_pk_bf16_f32 v103, v106, v107
    v_exp_f32 v108, v108
    s_nop 0
    v_cvt_pk_bf16_f32 v116, v108, 0
    v_mfma_f32_16x16x32_bf16 v[52:55], v[72:75], v[84:87], 0
    v_mfma_f32_16x16x32_bf16 v[52:55], v[76:79], v[92:95], v[52:55]
    v_mfma_f32_16x16x32_bf16 v[52:55], v[80:83], v[100:103], v[52:55]
    v_mfma_f32_16x16x32_bf16 v[52:55], v[70:73], v[116:119], v[52:55]
    s_nop 7
    v_rcp_f32 v112, v54
    s_nop 0
    v_fma_f32 v113, v52, v112, v48
    v_fma_f32 v114, v53, v112, v49
    v_cvt_pk_bf16_f32 v115, v113, v114
    v_pk_max_i16 v115, v115, v9
    buffer_store_dword v115, v2, s[20:23], 0 offen offset:2064
    v_mfma_f32_16x16x16_bf16 v[44:47], v[26:27], v[20:21], 0
    v_mfma_f32_16x16x16_bf16 v[48:51], v[30:31], v[20:21], 0
    s_nop 6
    v_cvt_pk_bf16_f32 v36, v44, v45
    v_cvt_pk_bf16_f32 v37, v46, v47
    s_nop 1
    v_mfma_f32_16x16x16_bf16 v[84:87], v[10:11], v[36:37], 0
    v_mfma_f32_16x16x16_bf16 v[88:91], v[12:13], v[36:37], 0
    v_mfma_f32_16x16x16_bf16 v[92:95], v[14:15], v[36:37], 0
    v_mfma_f32_16x16x16_bf16 v[96:99], v[16:17], v[36:37], 0
    v_mfma_f32_16x16x16_bf16 v[100:103], v[18:19], v[36:37], 0
    v_mfma_f32_16x16x16_bf16 v[104:107], v[20:21], v[36:37], 0
    v_mfma_f32_16x16x16_bf16 v[108:111], v[22:23], v[36:37], 0
    s_nop 1
    v_max3_f32 v112, v84, v85, v86
    v_max3_f32 v112, v112, v87, v88
    v_max3_f32 v112, v112, v89, v90
    v_max3_f32 v112, v112, v91, v92
    v_max3_f32 v112, v112, v93, v94
    v_max3_f32 v112, v112, v95, v96
    v_max3_f32 v112, v112, v97, v98
    v_max3_f32 v112, v112, v99, v100
    v_max3_f32 v112, v112, v101, v102
    v_max3_f32 v112, v112, v103, v104
    v_max3_f32 v112, v112, v105, v106
    v_max3_f32 v112, v112, v107, v108
    v_mov_b32 v113, v112
    s_nop 1
    v_permlane32_swap_b32 v112, v113
    v_max_f32 v112, v112, v113
    v_mov_b32 v113, v112
    s_nop 1
    v_permlane16_swap_b32 v112, v113
    v_max_f32 v112, v112, v113
    v_mul_f32 v40, -1.0, v112
    v_mul_f32 v41, -1.0, v112
    v_mul_f32 v42, -1.0, v112
    v_mul_f32 v43, -1.0, v112
    s_nop 1
    v_mfma_f32_16x16x16_bf16 v[84:87], v[10:11], v[36:37], v[40:43]
    v_mfma_f32_16x16x16_bf16 v[88:91], v[12:13], v[36:37], v[40:43]
    v_mfma_f32_16x16x16_bf16 v[92:95], v[14:15], v[36:37], v[40:43]
    v_mfma_f32_16x16x16_bf16 v[96:99], v[16:17], v[36:37], v[40:43]
    v_mfma_f32_16x16x16_bf16 v[100:103], v[18:19], v[36:37], v[40:43]
    v_mfma_f32_16x16x16_bf16 v[104:107], v[20:21], v[36:37], v[40:43]
    v_mfma_f32_16x16x16_bf16 v[108:111], v[22:23], v[36:37], v[40:43]
    s_nop 1
    v_exp_f32 v84, v84
    v_exp_f32 v85, v85
    v_exp_f32 v86, v86
    v_exp_f32 v87, v87
    v_exp_f32 v88, v88
    v_exp_f32 v89, v89
    v_exp_f32 v90, v90
    v_exp_f32 v91, v91
    v_cvt_pk_bf16_f32 v84, v84, v85
    v_cvt_pk_bf16_f32 v85, v86, v87
    v_cvt_pk_bf16_f32 v86, v88, v89
    v_cvt_pk_bf16_f32 v87, v90, v91
    v_exp_f32 v92, v92
    v_exp_f32 v93, v93
    v_exp_f32 v94, v94
    v_exp_f32 v95, v95
    v_exp_f32 v96, v96
    v_exp_f32 v97, v97
    v_exp_f32 v98, v98
    v_exp_f32 v99, v99
    v_cvt_pk_bf16_f32 v92, v92, v93
    v_cvt_pk_bf16_f32 v93, v94, v95
    v_cvt_pk_bf16_f32 v94, v96, v97
    v_cvt_pk_bf16_f32 v95, v98, v99
    v_exp_f32 v100, v100
    v_exp_f32 v101, v101
    v_exp_f32 v102, v102
    v_exp_f32 v103, v103
    v_exp_f32 v104, v104
    v_exp_f32 v105, v105
    v_exp_f32 v106, v106
    v_exp_f32 v107, v107
    v_cvt_pk_bf16_f32 v100, v100, v101
    v_cvt_pk_bf16_f32 v101, v102, v103
    v_cvt_pk_bf16_f32 v102, v104, v105
    v_cvt_pk_bf16_f32 v103, v106, v107
    v_exp_f32 v108, v108
    s_nop 0
    v_cvt_pk_bf16_f32 v116, v108, 0
    v_mfma_f32_16x16x32_bf16 v[52:55], v[58:61], v[84:87], 0
    v_mfma_f32_16x16x32_bf16 v[52:55], v[62:65], v[92:95], v[52:55]
    v_mfma_f32_16x16x32_bf16 v[52:55], v[66:69], v[100:103], v[52:55]
    v_mfma_f32_16x16x32_bf16 v[52:55], v[56:59], v[116:119], v[52:55]
    s_nop 7
    v_rcp_f32 v112, v54
    s_nop 0
    v_fma_f32 v113, v52, v112, v48
    v_fma_f32 v114, v53, v112, v49
    v_cvt_pk_bf16_f32 v115, v113, v114
    v_pk_max_i16 v115, v115, v9
    buffer_store_dword v115, v2, s[20:23], 0 offen offset:2560
    v_mfma_f32_16x16x16_bf16 v[44:47], v[28:29], v[20:21], 0
    v_mfma_f32_16x16x16_bf16 v[48:51], v[32:33], v[20:21], 0
    s_nop 6
    v_cvt_pk_bf16_f32 v36, v44, v45
    v_cvt_pk_bf16_f32 v37, v46, v47
    s_nop 1
    v_mfma_f32_16x16x16_bf16 v[84:87], v[10:11], v[36:37], 0
    v_mfma_f32_16x16x16_bf16 v[88:91], v[12:13], v[36:37], 0
    v_mfma_f32_16x16x16_bf16 v[92:95], v[14:15], v[36:37], 0
    v_mfma_f32_16x16x16_bf16 v[96:99], v[16:17], v[36:37], 0
    v_mfma_f32_16x16x16_bf16 v[100:103], v[18:19], v[36:37], 0
    v_mfma_f32_16x16x16_bf16 v[104:107], v[20:21], v[36:37], 0
    v_mfma_f32_16x16x16_bf16 v[108:111], v[22:23], v[36:37], 0
    s_nop 1
    v_max3_f32 v112, v84, v85, v86
    v_max3_f32 v112, v112, v87, v88
    v_max3_f32 v112, v112, v89, v90
    v_max3_f32 v112, v112, v91, v92
    v_max3_f32 v112, v112, v93, v94
    v_max3_f32 v112, v112, v95, v96
    v_max3_f32 v112, v112, v97, v98
    v_max3_f32 v112, v112, v99, v100
    v_max3_f32 v112, v112, v101, v102
    v_max3_f32 v112, v112, v103, v104
    v_max3_f32 v112, v112, v105, v106
    v_max3_f32 v112, v112, v107, v108
    v_mov_b32 v113, v112
    s_nop 1
    v_permlane32_swap_b32 v112, v113
    v_max_f32 v112, v112, v113
    v_mov_b32 v113, v112
    s_nop 1
    v_permlane16_swap_b32 v112, v113
    v_max_f32 v112, v112, v113
    v_mul_f32 v40, -1.0, v112
    v_mul_f32 v41, -1.0, v112
    v_mul_f32 v42, -1.0, v112
    v_mul_f32 v43, -1.0, v112
    s_nop 1
    v_mfma_f32_16x16x16_bf16 v[84:87], v[10:11], v[36:37], v[40:43]
    v_mfma_f32_16x16x16_bf16 v[88:91], v[12:13], v[36:37], v[40:43]
    v_mfma_f32_16x16x16_bf16 v[92:95], v[14:15], v[36:37], v[40:43]
    v_mfma_f32_16x16x16_bf16 v[96:99], v[16:17], v[36:37], v[40:43]
    v_mfma_f32_16x16x16_bf16 v[100:103], v[18:19], v[36:37], v[40:43]
    v_mfma_f32_16x16x16_bf16 v[104:107], v[20:21], v[36:37], v[40:43]
    v_mfma_f32_16x16x16_bf16 v[108:111], v[22:23], v[36:37], v[40:43]
    s_nop 1
    v_exp_f32 v84, v84
    v_exp_f32 v85, v85
    v_exp_f32 v86, v86
    v_exp_f32 v87, v87
    v_exp_f32 v88, v88
    v_exp_f32 v89, v89
    v_exp_f32 v90, v90
    v_exp_f32 v91, v91
    v_cvt_pk_bf16_f32 v84, v84, v85
    v_cvt_pk_bf16_f32 v85, v86, v87
    v_cvt_pk_bf16_f32 v86, v88, v89
    v_cvt_pk_bf16_f32 v87, v90, v91
    v_exp_f32 v92, v92
    v_exp_f32 v93, v93
    v_exp_f32 v94, v94
    v_exp_f32 v95, v95
    v_exp_f32 v96, v96
    v_exp_f32 v97, v97
    v_exp_f32 v98, v98
    v_exp_f32 v99, v99
    v_cvt_pk_bf16_f32 v92, v92, v93
    v_cvt_pk_bf16_f32 v93, v94, v95
    v_cvt_pk_bf16_f32 v94, v96, v97
    v_cvt_pk_bf16_f32 v95, v98, v99
    v_exp_f32 v100, v100
    v_exp_f32 v101, v101
    v_exp_f32 v102, v102
    v_exp_f32 v103, v103
    v_exp_f32 v104, v104
    v_exp_f32 v105, v105
    v_exp_f32 v106, v106
    v_exp_f32 v107, v107
    v_cvt_pk_bf16_f32 v100, v100, v101
    v_cvt_pk_bf16_f32 v101, v102, v103
    v_cvt_pk_bf16_f32 v102, v104, v105
    v_cvt_pk_bf16_f32 v103, v106, v107
    v_exp_f32 v108, v108
    s_nop 0
    v_cvt_pk_bf16_f32 v116, v108, 0
    v_mfma_f32_16x16x32_bf16 v[52:55], v[72:75], v[84:87], 0
    v_mfma_f32_16x16x32_bf16 v[52:55], v[76:79], v[92:95], v[52:55]
    v_mfma_f32_16x16x32_bf16 v[52:55], v[80:83], v[100:103], v[52:55]
    v_mfma_f32_16x16x32_bf16 v[52:55], v[70:73], v[116:119], v[52:55]
    s_nop 7
    v_rcp_f32 v112, v54
    s_nop 0
    v_fma_f32 v113, v52, v112, v48
    v_fma_f32 v114, v53, v112, v49
    v_cvt_pk_bf16_f32 v115, v113, v114
    v_pk_max_i16 v115, v115, v9
    buffer_store_dword v115, v2, s[20:23], 0 offen offset:2576
    v_mfma_f32_16x16x16_bf16 v[44:47], v[26:27], v[24:25], 0
    v_mfma_f32_16x16x16_bf16 v[40:43], v[28:29], v[24:25], 0
    v_mfma_f32_16x16x16_bf16 v[48:51], v[30:31], v[24:25], 0
    s_nop 5
    v_cvt_pk_bf16_f32 v36, v44, v45
    v_cvt_pk_bf16_f32 v37, v46, v47
    v_cvt_pk_bf16_f32 v38, v40, v41
    v_cvt_pk_bf16_f32 v39, v42, v43
    v_cndmask_b32_e64 v36, v36, v38, s[48:49]
    v_cndmask_b32_e64 v37, v37, v39, s[48:49]
    s_nop 1
    v_mfma_f32_16x16x16_bf16 v[84:87], v[10:11], v[36:37], 0
    v_mfma_f32_16x16x16_bf16 v[88:91], v[12:13], v[36:37], 0
    v_mfma_f32_16x16x16_bf16 v[92:95], v[14:15], v[36:37], 0
    v_mfma_f32_16x16x16_bf16 v[96:99], v[16:17], v[36:37], 0
    v_mfma_f32_16x16x16_bf16 v[100:103], v[18:19], v[36:37], 0
    v_mfma_f32_16x16x16_bf16 v[104:107], v[20:21], v[36:37], 0
    v_mfma_f32_16x16x16_bf16 v[108:111], v[22:23], v[36:37], 0
    s_nop 1
    v_max3_f32 v112, v84, v85, v86
    v_max3_f32 v112, v112, v87, v88
    v_max3_f32 v112, v112, v89, v90
    v_max3_f32 v112, v112, v91, v92
    v_max3_f32 v112, v112, v93, v94
    v_max3_f32 v112, v112, v95, v96
    v_max3_f32 v112, v112, v97, v98
    v_max3_f32 v112, v112, v99, v100
    v_max3_f32 v112, v112, v101, v102
    v_max3_f32 v112, v112, v103, v104
    v_max3_f32 v112, v112, v105, v106
    v_max3_f32 v112, v112, v107, v108
    v_mov_b32 v113, v112
    s_nop 1
    v_permlane32_swap_b32 v112, v113
    v_max_f32 v112, v112, v113
    v_mov_b32 v113, v112
    s_nop 1
    v_permlane16_swap_b32 v112, v113
    v_max_f32 v112, v112, v113
    v_mul_f32 v40, -1.0, v112
    v_mul_f32 v41, -1.0, v112
    v_mul_f32 v42, -1.0, v112
    v_mul_f32 v43, -1.0, v112
    s_nop 1
    v_mfma_f32_16x16x16_bf16 v[84:87], v[10:11], v[36:37], v[40:43]
    v_mfma_f32_16x16x16_bf16 v[88:91], v[12:13], v[36:37], v[40:43]
    v_mfma_f32_16x16x16_bf16 v[92:95], v[14:15], v[36:37], v[40:43]
    v_mfma_f32_16x16x16_bf16 v[96:99], v[16:17], v[36:37], v[40:43]
    v_mfma_f32_16x16x16_bf16 v[100:103], v[18:19], v[36:37], v[40:43]
    v_mfma_f32_16x16x16_bf16 v[104:107], v[20:21], v[36:37], v[40:43]
    v_mfma_f32_16x16x16_bf16 v[108:111], v[22:23], v[36:37], v[40:43]
    s_nop 1
    v_exp_f32 v84, v84
    v_exp_f32 v85, v85
    v_exp_f32 v86, v86
    v_exp_f32 v87, v87
    v_exp_f32 v88, v88
    v_exp_f32 v89, v89
    v_exp_f32 v90, v90
    v_exp_f32 v91, v91
    v_cvt_pk_bf16_f32 v84, v84, v85
    v_cvt_pk_bf16_f32 v85, v86, v87
    v_cvt_pk_bf16_f32 v86, v88, v89
    v_cvt_pk_bf16_f32 v87, v90, v91
    v_exp_f32 v92, v92
    v_exp_f32 v93, v93
    v_exp_f32 v94, v94
    v_exp_f32 v95, v95
    v_exp_f32 v96, v96
    v_exp_f32 v97, v97
    v_exp_f32 v98, v98
    v_exp_f32 v99, v99
    v_cvt_pk_bf16_f32 v92, v92, v93
    v_cvt_pk_bf16_f32 v93, v94, v95
    v_cvt_pk_bf16_f32 v94, v96, v97
    v_cvt_pk_bf16_f32 v95, v98, v99
    v_exp_f32 v100, v100
    v_exp_f32 v101, v101
    v_exp_f32 v102, v102
    v_exp_f32 v103, v103
    v_exp_f32 v104, v104
    v_exp_f32 v105, v105
    v_exp_f32 v106, v106
    v_exp_f32 v107, v107
    v_cvt_pk_bf16_f32 v100, v100, v101
    v_cvt_pk_bf16_f32 v101, v102, v103
    v_cvt_pk_bf16_f32 v102, v104, v105
    v_cvt_pk_bf16_f32 v103, v106, v107
    v_exp_f32 v108, v108
    s_nop 0
    v_cvt_pk_bf16_f32 v116, v108, 0
    v_mfma_f32_16x16x32_bf16 v[52:55], v[58:61], v[84:87], 0
    v_mfma_f32_16x16x32_bf16 v[52:55], v[62:65], v[92:95], v[52:55]
    v_mfma_f32_16x16x32_bf16 v[52:55], v[66:69], v[100:103], v[52:55]
    v_mfma_f32_16x16x32_bf16 v[52:55], v[56:59], v[116:119], v[52:55]
    s_nop 7
    v_rcp_f32 v112, v54
    s_nop 0
    v_fma_f32 v113, v52, v112, v48
    v_fma_f32 v114, v53, v112, v49
    v_cvt_pk_bf16_f32 v115, v113, v114
    v_pk_max_i16 v115, v115, v9
    buffer_store_dword v115, v3, s[20:23], 0 offen offset:0
    v_mfma_f32_16x16x16_bf16 v[48:51], v[32:33], v[24:25], 0
    v_mfma_f32_16x16x32_bf16 v[52:55], v[72:75], v[84:87], 0
    v_mfma_f32_16x16x32_bf16 v[52:55], v[76:79], v[92:95], v[52:55]
    v_mfma_f32_16x16x32_bf16 v[52:55], v[80:83], v[100:103], v[52:55]
    v_mfma_f32_16x16x32_bf16 v[52:55], v[70:73], v[116:119], v[52:55]
    s_nop 7
    v_rcp_f32 v112, v54
    s_nop 0
    v_fma_f32 v113, v52, v112, v48
    v_fma_f32 v114, v53, v112, v49
    v_cvt_pk_bf16_f32 v115, v113, v114
    v_pk_max_i16 v115, v115, v9
    buffer_store_dword v115, v4, s[20:23], 0 offen offset:16
L_end:
    s_endpgm
.section .rodata,"a"
.p2align 6
.amdhsa_kernel standalone__attention_interact_autoint__recsys_kernel
  .amdhsa_next_free_vgpr 128
  .amdhsa_next_free_sgpr 64
  .amdhsa_accum_offset 128
  .amdhsa_group_segment_fixed_size 0
  .amdhsa_kernarg_size 64
  .amdhsa_user_sgpr_count 2
  .amdhsa_user_sgpr_kernarg_segment_ptr 1
  .amdhsa_system_sgpr_workgroup_id_x 1
.end_amdhsa_kernel
```
